```python
import torch

def _softmax(x, axis=-1):
    return torch.softmax(x, dim=axis)
def _gelu(x):
    return torch.nn.functional.gelu(x, approximate="tanh")
def _silu(x):
    return torch.nn.functional.silu(x)
def _sigmoid(x):
    return torch.sigmoid(x)
def _layernorm(x, axis=-1, eps=1e-5):
    m = x.mean(dim=axis, keepdim=True)
    v = x.var(dim=axis, keepdim=True, unbiased=False)
    return (x - m) / torch.sqrt(v + eps)
def _scatter_add(tgt, idx, src, axis=0):
    return tgt.clone().index_add_(axis, idx, src)
def _segment_sum(src, seg, n):
    out = torch.zeros((n,) + src.shape[1:], dtype=src.dtype)
    return out.index_add_(0, seg, src)
def _pad(x, pw):
    flat = tuple(v for pair in reversed(pw) for v in pair)
    return torch.nn.functional.pad(x, flat)

kernel_name = 'gated_mix__sliding_block__softmax_full_mha__prompt'

def setup_inputs():

    _w = (lambda a: (lambda t: t.to(torch.bfloat16) if t.is_floating_point() else t)(torch.as_tensor(a)))
    def _A_setup():
        B, S, D = 1, 2048, 448
        return {
            "x": _w((lambda *s: torch.randn(*s, dtype=torch.bfloat16) * 0.05)(B, S, D)),
            "wqkv": _w((lambda *s: torch.randn(*s, dtype=torch.bfloat16) * 1.6)(D, 3 * D)),
            "wo": _w((lambda *s: torch.randn(*s, dtype=torch.bfloat16) * 0.05)(D, D)),
        }
    _A_in = _A_setup()

    def _B_setup():
        B, S, D = 1, 2048, 448
        return {
            "x": _w((lambda *s: torch.randn(*s, dtype=torch.bfloat16) * 0.05)(B, S, D)),
            "wqkv": _w((lambda *s: torch.randn(*s, dtype=torch.bfloat16) * 1.6)(D, 3 * D)),
            "wo": _w((lambda *s: torch.randn(*s, dtype=torch.bfloat16) * 0.1)(D, D)),
        }
    _B_in = _B_setup()

    return {
        "A_x": _A_in["x"],
        "A_wqkv": _A_in["wqkv"],
        "A_wo": _A_in["wo"],
        "B_x": _B_in["x"],
        "B_wqkv": _B_in["wqkv"],
        "B_wo": _B_in["wo"],
        "gate_w": _w((lambda *s: torch.randn(*s, dtype=torch.bfloat16) * 0.05)(448) * 16.0),
    }

def reference(A_x, A_wqkv, A_wo, B_x, B_wqkv, B_wo, gate_w):
    def _A_ref(x, wqkv, wo):
        B, S, D = x.shape
        H = 16; Dh = D // H; W = 256
        qkv = (lambda x, *d: x.permute(*d))((x @ wqkv).reshape(B, S, 3, H, Dh), 2, 0, 3, 1, 4)
        q, k, v = qkv[0], qkv[1], qkv[2]
        scores = torch.einsum("bhqd,bhkd->bhqk", q, k) * (Dh ** -0.5)
        idx = torch.arange(S)
        mask = (idx[:, None] - idx[None, :] >= 0) & (idx[:, None] - idx[None, :] < W)
        scores = torch.where(mask[None, None], scores, -1e9)
        p = _softmax(scores, axis=-1)
        o = torch.einsum("bhqk,bhkd->bhqd", p, v)
        return (lambda x, *d: x.permute(*d))(o, 0, 2, 1, 3).reshape(B, S, D) @ wo

    def _B_ref(x, wqkv, wo):
        B, S, D = x.shape
        H = 16; Dh = D // H
        qkv = (lambda x, *d: x.permute(*d))((x @ wqkv).reshape(B, S, 3, H, Dh), 2, 0, 3, 1, 4)
        q, k, v = qkv[0], qkv[1], qkv[2]
        scale = Dh ** -0.5
        scores = torch.einsum("bhqd,bhkd->bhqk", q, k) * scale
        p = _softmax(scores, axis=-1)
        o = torch.einsum("bhqk,bhkd->bhqd", p, v)
        return (lambda x, *d: x.permute(*d))(o, 0, 2, 1, 3).reshape(B, S, D) @ wo

    x = A_x
    g = _sigmoid((x * gate_w).sum(-1, keepdims=True))
    a = _A_ref(x, A_wqkv, A_wo)
    b = _B_ref(x, B_wqkv, B_wo)
    return g * a + (1 - g) * b
```

```asm
; @launch grid=(256,1,1) block=(512,1,1) lds=163840
.amdgcn_target "amdgcn-amd-amdhsa--gfx950"
.text
.globl gated_mix__sliding_block__softmax_full_mha__prompt_kernel
.p2align 8
.type gated_mix__sliding_block__softmax_full_mha__prompt_kernel,@function
gated_mix__sliding_block__softmax_full_mha__prompt_kernel:
  s_cmp_ge_u32 s2, 256
  s_cbranch_scc1 L_end
  s_load_dwordx8 s[4:11], s[0:1], 0
  s_load_dwordx8 s[12:19], s[0:1], 32
  s_load_dwordx4 s[20:23], s[0:1], 64
  s_getpc_b64 s[24:25]
L_pc:
  s_lshr_b32 s64, s2, 3
  s_mul_i32 s64, s64, 10
  v_min_u32 v2, 9, v0
  v_add_lshl_u32 v2, v2, s64, 7
  v_min_u32 v2, L_code_end-L_pc-4, v2
  v_cmp_gt_u32 vcc, 64, v0
  s_cbranch_vccz L_nocpf
  global_load_dword v8, v2, s[24:25]
L_nocpf:
  v_lshrrev_b32 v1, 6, v0
  v_and_b32 v0, 63, v0
  v_readfirstlane_b32 s50, v1
  v_lshlrev_b32 v1, 4, v0
  s_and_b32 s64, s2, 6
  s_lshl_b32 s64, s64, 1
  s_lshr_b32 s65, s2, 6
  s_add_u32 s48, s64, s65
  s_and_b32 s64, s2, 1
  s_lshl_b32 s64, s64, 3
  s_bfe_u32 s66, s2, 0x30003
  s_add_u32 s49, s64, s66
  s_lshl_b32 s65, s65, 1
  s_add_u32 s63, s65, s66
  s_cmp_ge_u32 s63, 7
  s_cselect_b32 s65, 7, 0
  s_sub_u32 s63, s63, s65
  s_lshr_b32 s65, s2, 6
  s_add_u32 s65, s65, s66
  s_and_b32 s65, s65, 3
  s_lshl_b32 s63, s65, 1
  s_mov_b32 s66, 0xdc549018
  s_mov_b32 s67, 0xfe76ba32
  s_lshl_b32 s64, s48, 2
  s_lshr_b64 s[66:67], s[66:67], s64
  s_and_b32 s53, s66, 15
  s_lshr_b32 s51, s50, 2
  s_and_b32 s52, s50, 3
  v_mov_b32 v255, 0
  s_cmp_lt_u32 s50, 4
  s_cbranch_scc1 L_compute
  s_bitcmp1_b32 s53, 2
  s_cselect_b32 s66, 16, 8
  s_cselect_b32 s67, 4, 16
  s_cselect_b32 s60, 3, 2
  s_mulk_i32 s66, 896
  s_mulk_i32 s67, 896
  v_bfe_u32 v2, v0, 3, 2
  v_lshrrev_b32 v3, 5, v0
  v_lshl_add_u32 v2, v3, s60, v2
  s_lshl_b32 s64, s49, 7
  s_lshl_b32 s65, s52, 5
  s_add_u32 s64, s64, s65
  v_add_u32 v2, s64, v2
  v_mul_u32_u24 v2, 896, v2
  v_lshrrev_b32 v3, 4, v0
  v_and_b32 v4, 7, v0
  v_xor_b32 v3, v3, v4
  v_lshlrev_b32 v3, 4, v3
  v_xor_b32 v4, 64, v3
  v_add_u32 v192, v2, v3
  v_add3_u32 v193, v2, v4, s66
  v_add_u32 v194, s67, v192
  v_add_u32 v195, s67, v193
  s_and_b32 s64, s53, 7
  s_mul_i32 s64, s64, 224
  s_add_u32 s64, s64, 896
  s_mul_i32 s65, s52, 43008
  s_add_u32 s64, s64, s65
  v_mul_u32_u24 v3, 4682, v0
  v_lshrrev_b32 v3, 16, v3
  v_mul_u32_u24 v4, 14, v3
  v_sub_u32 v4, v0, v4
  v_bfe_u32 v5, v3, 2, 1
  v_bfe_u32 v6, v3, 3, 1
  v_and_b32 v3, 3, v3
  v_lshl_or_b32 v3, v5, 3, v3
  v_lshl_or_b32 v3, v6, 2, v3
  v_mul_u32_u24 v3, 2688, v3
  v_lshl_add_u32 v3, v4, 4, v3
  v_add_u32 v196, s64, v3
  v_add_u32 v2, 64, v0
  v_mul_u32_u24 v3, 4682, v2
  v_lshrrev_b32 v3, 16, v3
  v_mul_u32_u24 v4, 14, v3
  v_sub_u32 v4, v2, v4
  v_bfe_u32 v5, v3, 2, 1
  v_bfe_u32 v6, v3, 3, 1
  v_and_b32 v3, 3, v3
  v_lshl_or_b32 v3, v5, 3, v3
  v_lshl_or_b32 v3, v6, 2, v3
  v_mul_u32_u24 v3, 2688, v3
  v_lshl_add_u32 v3, v4, 4, v3
  v_add_u32 v197, s64, v3
  v_add_u32 v2, 128, v0
  v_mul_u32_u24 v3, 4682, v2
  v_lshrrev_b32 v3, 16, v3
  v_mul_u32_u24 v4, 14, v3
  v_sub_u32 v4, v2, v4
  v_bfe_u32 v5, v3, 2, 1
  v_bfe_u32 v6, v3, 3, 1
  v_and_b32 v3, 3, v3
  v_lshl_or_b32 v3, v5, 3, v3
  v_lshl_or_b32 v3, v6, 2, v3
  v_mul_u32_u24 v3, 2688, v3
  v_lshl_add_u32 v3, v4, 4, v3
  v_add_u32 v198, s64, v3
  v_add_u32 v2, 192, v0
  v_mul_u32_u24 v3, 4682, v2
  v_lshrrev_b32 v3, 16, v3
  v_mul_u32_u24 v4, 14, v3
  v_sub_u32 v4, v2, v4
  v_bfe_u32 v5, v3, 2, 1
  v_bfe_u32 v6, v3, 3, 1
  v_and_b32 v3, 3, v3
  v_lshl_or_b32 v3, v5, 3, v3
  v_lshl_or_b32 v3, v6, 2, v3
  v_mul_u32_u24 v3, 2688, v3
  v_lshl_add_u32 v3, v4, 4, v3
  v_add_u32 v199, s64, v3
  s_lshl_b32 s60, s63, 7
  s_mul_i32 s61, s63, 172032
  s_waitcnt lgkmcnt(0)
  s_lshl_b32 s10, s52, 12
  s_mul_i32 s11, s52, 3584
  s_mov_b32 s32, s4
  s_mov_b32 s33, s5
  s_mov_b32 s34, 1835008
  s_mov_b32 s35, 0x00020000
  s_cmp_lt_u32 s53, 8
  s_cselect_b32 s36, s6, s12
  s_cselect_b32 s37, s7, s13
  s_mov_b32 s38, 1204224
  s_mov_b32 s39, 0x00020000
  s_add_u32 m0, s10, 1024
  s_nop 0
  buffer_load_dwordx4 v192, s[32:35], s60 offen lds
  s_add_u32 m0, s11, 17408
  s_nop 0
  buffer_load_dwordx4 v196, s[36:39], s61 offen lds
  s_add_u32 m0, s10, 2048
  s_nop 0
  buffer_load_dwordx4 v193, s[32:35], s60 offen lds
  s_add_u32 m0, s11, 18432
  s_nop 0
  buffer_load_dwordx4 v197, s[36:39], s61 offen lds
  s_add_u32 m0, s10, 3072
  s_nop 0
  buffer_load_dwordx4 v194, s[32:35], s60 offen lds
  s_add_u32 m0, s11, 19456
  s_nop 0
  buffer_load_dwordx4 v198, s[36:39], s61 offen lds
  s_add_u32 m0, s10, 4096
  s_nop 0
  buffer_load_dwordx4 v195, s[32:35], s60 offen lds
  s_add_u32 m0, s11, 20480
  s_mov_b32 exec_hi, 0
  buffer_load_dwordx4 v199, s[36:39], s61 offen lds
  s_mov_b32 exec_hi, -1
  s_add_u32 s60, s60, 128
  s_add_u32 s61, s61, 172032
  s_cmp_eq_u32 s60, 896
  s_cselect_b32 s60, 0, s60
  s_cselect_b32 s61, 0, s61
  s_add_u32 m0, s10, 31744
  s_nop 0
  buffer_load_dwordx4 v192, s[32:35], s60 offen lds
  s_add_u32 m0, s11, 48128
  s_nop 0
  buffer_load_dwordx4 v196, s[36:39], s61 offen lds
  s_add_u32 m0, s10, 32768
  s_nop 0
  buffer_load_dwordx4 v193, s[32:35], s60 offen lds
  s_add_u32 m0, s11, 49152
  s_nop 0
  buffer_load_dwordx4 v197, s[36:39], s61 offen lds
  s_add_u32 m0, s10, 33792
  s_nop 0
  buffer_load_dwordx4 v194, s[32:35], s60 offen lds
  s_add_u32 m0, s11, 50176
  s_nop 0
  buffer_load_dwordx4 v198, s[36:39], s61 offen lds
  s_add_u32 m0, s10, 34816
  s_nop 0
  buffer_load_dwordx4 v195, s[32:35], s60 offen lds
  s_add_u32 m0, s11, 51200
  s_mov_b32 exec_hi, 0
  buffer_load_dwordx4 v199, s[36:39], s61 offen lds
  s_mov_b32 exec_hi, -1
  s_add_u32 s60, s60, 128
  s_add_u32 s61, s61, 172032
  s_cmp_eq_u32 s60, 896
  s_cselect_b32 s60, 0, s60
  s_cselect_b32 s61, 0, s61
  s_mov_b32 s40, s12
  s_mov_b32 s41, s13
  s_mov_b32 s42, 1204224
  s_mov_b32 s43, 0x00020000
  v_lshrrev_b32 v2, 2, v0
  v_mul_u32_u24 v2, 2688, v2
  v_lshrrev_b32 v3, 4, v0
  v_and_b32 v3, 2, v3
  v_xor_b32 v3, v3, v0
  v_and_b32 v3, 3, v3
  v_lshl_add_u32 v2, v3, 4, v2
  s_mul_i32 s64, s48, 56
  v_add_u32 v200, s64, v2
  s_mul_i32 s58, s52, 7168
  s_add_u32 s58, s58, 106496
  s_mul_i32 s64, s52, 7
  s_lshl_b32 s65, s63, 2
  s_add_u32 s64, s64, s65
  s_cmp_ge_u32 s64, 28
  s_cselect_b32 s65, 28, 0
  s_sub_u32 s64, s64, s65
  s_mul_i32 s62, s64, 43008
  s_mov_b32 s0, s62
  s_add_u32 m0, s58, 0
  s_nop 0
  buffer_load_dwordx4 v200, s[40:43], s62 offen lds
  s_add_u32 s62, s62, 43008
  s_cmp_eq_u32 s62, 1204224
  s_cselect_b32 s62, 0, s62
  s_mov_b32 s28, s6
  s_mov_b32 s29, s7
  s_mov_b32 s30, 1204224
  s_mov_b32 s31, 0x00020000
  v_lshlrev_b32 v2, 2, v0
  ds_write_b32 v2, v255
  s_mov_b32 s44, s16
  s_mov_b32 s45, s17
  s_mov_b32 s46, 896
  s_mov_b32 s47, 0x00020000
  s_mul_i32 s64, s52, 112
  s_lshl_b32 s65, s63, 6
  s_add_u32 s65, s65, s64
  v_min_u32 v2, 55, v0
  v_add_u32 v3, s65, v2
  v_add_u32 v2, s64, v2
  v_add_u32 v4, 0, v2
  v_and_b32 v5, 8, v4
  v_lshlrev_b32 v5, 2, v5
  v_xor_b32 v5, 56, v5
  v_lshl_add_u32 v4, v4, 6, v5
  v_add_u32 v204, 106496, v4
  v_add_u32 v4, 56, v2
  v_and_b32 v5, 8, v4
  v_lshlrev_b32 v5, 2, v5
  v_xor_b32 v5, 56, v5
  v_lshl_add_u32 v4, v4, 6, v5
  v_add_u32 v205, 106496, v4
  v_add_u32 v4, 0, v3
  v_subrev_u32 v5, 448, v4
  v_min_u32 v4, v4, v5
  v_lshlrev_b32 v4, 1, v4
  buffer_load_ushort v202, v4, s[44:47], 0 offen
  v_add_u32 v4, 56, v3
  v_subrev_u32 v5, 448, v4
  v_min_u32 v4, v4, v5
  v_lshlrev_b32 v4, 1, v4
  buffer_load_ushort v203, v4, s[44:47], 0 offen
  s_mov_b32 s44, s20
  s_mov_b32 s45, s21
  s_mov_b32 s46, 256
  s_mov_b32 s47, 0x00020000
  s_waitcnt lgkmcnt(0)
  s_waitcnt vmcnt(11)
  s_barrier
  s_add_u32 m0, s10, 62464
  s_nop 0
  buffer_load_dwordx4 v192, s[32:35], s60 offen lds
  s_add_u32 m0, s11, 78848
  s_nop 0
  buffer_load_dwordx4 v196, s[36:39], s61 offen lds
  s_add_u32 m0, s10, 63488
  s_nop 0
  buffer_load_dwordx4 v193, s[32:35], s60 offen lds
  s_add_u32 m0, s11, 79872
  s_nop 0
  buffer_load_dwordx4 v197, s[36:39], s61 offen lds
  s_add_u32 m0, s10, 64512
  s_nop 0
  buffer_load_dwordx4 v194, s[32:35], s60 offen lds
  s_add_u32 m0, s11, 80896
  s_nop 0
  buffer_load_dwordx4 v198, s[36:39], s61 offen lds
  s_add_u32 m0, s10, 65536
  s_nop 0
  buffer_load_dwordx4 v195, s[32:35], s60 offen lds
  s_add_u32 m0, s11, 81920
  s_mov_b32 exec_hi, 0
  buffer_load_dwordx4 v199, s[36:39], s61 offen lds
  s_mov_b32 exec_hi, -1
  s_add_u32 s60, s60, 128
  s_add_u32 s61, s61, 172032
  s_cmp_eq_u32 s60, 896
  s_cselect_b32 s60, 0, s60
  s_cselect_b32 s61, 0, s61
  s_waitcnt vmcnt(11)
  s_barrier
  s_add_u32 m0, s10, 1024
  s_nop 0
  buffer_load_dwordx4 v192, s[32:35], s60 offen lds
  s_add_u32 m0, s11, 17408
  s_nop 0
  buffer_load_dwordx4 v196, s[36:39], s61 offen lds
  s_add_u32 m0, s10, 2048
  s_nop 0
  buffer_load_dwordx4 v193, s[32:35], s60 offen lds
  s_add_u32 m0, s11, 18432
  s_nop 0
  buffer_load_dwordx4 v197, s[36:39], s61 offen lds
  s_add_u32 m0, s10, 3072
  s_nop 0
  buffer_load_dwordx4 v194, s[32:35], s60 offen lds
  s_add_u32 m0, s11, 19456
  s_nop 0
  buffer_load_dwordx4 v198, s[36:39], s61 offen lds
  s_add_u32 m0, s10, 4096
  s_nop 0
  buffer_load_dwordx4 v195, s[32:35], s60 offen lds
  s_add_u32 m0, s11, 20480
  s_mov_b32 exec_hi, 0
  buffer_load_dwordx4 v199, s[36:39], s61 offen lds
  s_mov_b32 exec_hi, -1
  s_add_u32 s60, s60, 128
  s_add_u32 s61, s61, 172032
  s_cmp_eq_u32 s60, 896
  s_cselect_b32 s60, 0, s60
  s_cselect_b32 s61, 0, s61
  s_cmp_lt_u32 s53, 8
  s_cbranch_scc0 L_nowarm
  s_add_u32 m0, s10, 135168
  s_nop 0
  buffer_load_dwordx4 v200, s[28:31], s0 offen lds
L_nowarm:
  s_waitcnt vmcnt(8)
  s_barrier
  s_add_u32 m0, s10, 31744
  s_nop 0
  buffer_load_dwordx4 v192, s[32:35], s60 offen lds
  s_add_u32 m0, s11, 48128
  s_nop 0
  buffer_load_dwordx4 v196, s[36:39], s61 offen lds
  s_add_u32 m0, s10, 32768
  s_nop 0
  buffer_load_dwordx4 v193, s[32:35], s60 offen lds
  s_add_u32 m0, s11, 49152
  s_nop 0
  buffer_load_dwordx4 v197, s[36:39], s61 offen lds
  s_add_u32 m0, s10, 33792
  s_nop 0
  buffer_load_dwordx4 v194, s[32:35], s60 offen lds
  s_add_u32 m0, s11, 50176
  s_nop 0
  buffer_load_dwordx4 v198, s[36:39], s61 offen lds
  s_add_u32 m0, s10, 34816
  s_nop 0
  buffer_load_dwordx4 v195, s[32:35], s60 offen lds
  s_add_u32 m0, s11, 51200
  s_mov_b32 exec_hi, 0
  buffer_load_dwordx4 v199, s[36:39], s61 offen lds
  s_mov_b32 exec_hi, -1
  s_add_u32 s60, s60, 128
  s_add_u32 s61, s61, 172032
  s_cmp_eq_u32 s60, 896
  s_cselect_b32 s60, 0, s60
  s_cselect_b32 s61, 0, s61
  s_add_u32 m0, s58, 1024
  s_nop 0
  buffer_load_dwordx4 v200, s[40:43], s62 offen lds
  s_add_u32 s62, s62, 43008
  s_cmp_eq_u32 s62, 1204224
  s_cselect_b32 s62, 0, s62
  s_waitcnt vmcnt(9)
  s_barrier
  s_add_u32 m0, s10, 62464
  s_nop 0
  buffer_load_dwordx4 v192, s[32:35], s60 offen lds
  s_add_u32 m0, s11, 78848
  s_nop 0
  buffer_load_dwordx4 v196, s[36:39], s61 offen lds
  s_add_u32 m0, s10, 63488
  s_nop 0
  buffer_load_dwordx4 v193, s[32:35], s60 offen lds
  s_add_u32 m0, s11, 79872
  s_nop 0
  buffer_load_dwordx4 v197, s[36:39], s61 offen lds
  s_add_u32 m0, s10, 64512
  s_nop 0
  buffer_load_dwordx4 v194, s[32:35], s60 offen lds
  s_add_u32 m0, s11, 80896
  s_nop 0
  buffer_load_dwordx4 v198, s[36:39], s61 offen lds
  s_add_u32 m0, s10, 65536
  s_nop 0
  buffer_load_dwordx4 v195, s[32:35], s60 offen lds
  s_add_u32 m0, s11, 81920
  s_mov_b32 exec_hi, 0
  buffer_load_dwordx4 v199, s[36:39], s61 offen lds
  s_mov_b32 exec_hi, -1
  s_add_u32 s60, s60, 128
  s_add_u32 s61, s61, 172032
  s_cmp_eq_u32 s60, 896
  s_cselect_b32 s60, 0, s60
  s_cselect_b32 s61, 0, s61
  s_add_u32 m0, s58, 2048
  s_nop 0
  buffer_load_dwordx4 v200, s[40:43], s62 offen lds
  s_add_u32 s62, s62, 43008
  s_cmp_eq_u32 s62, 1204224
  s_cselect_b32 s62, 0, s62
  s_waitcnt vmcnt(10)
  s_barrier
  s_add_u32 m0, s10, 1024
  s_nop 0
  buffer_load_dwordx4 v192, s[32:35], s60 offen lds
  s_add_u32 m0, s11, 17408
  s_nop 0
  buffer_load_dwordx4 v196, s[36:39], s61 offen lds
  s_add_u32 m0, s10, 2048
  s_nop 0
  buffer_load_dwordx4 v193, s[32:35], s60 offen lds
  s_add_u32 m0, s11, 18432
  s_nop 0
  buffer_load_dwordx4 v197, s[36:39], s61 offen lds
  s_add_u32 m0, s10, 3072
  s_nop 0
  buffer_load_dwordx4 v194, s[32:35], s60 offen lds
  s_add_u32 m0, s11, 19456
  s_nop 0
  buffer_load_dwordx4 v198, s[36:39], s61 offen lds
  s_add_u32 m0, s10, 4096
  s_nop 0
  buffer_load_dwordx4 v195, s[32:35], s60 offen lds
  s_add_u32 m0, s11, 20480
  s_mov_b32 exec_hi, 0
  buffer_load_dwordx4 v199, s[36:39], s61 offen lds
  s_mov_b32 exec_hi, -1
  s_add_u32 s60, s60, 128
  s_add_u32 s61, s61, 172032
  s_cmp_eq_u32 s60, 896
  s_cselect_b32 s60, 0, s60
  s_cselect_b32 s61, 0, s61
  s_add_u32 m0, s58, 3072
  s_nop 0
  buffer_load_dwordx4 v200, s[40:43], s62 offen lds
  s_add_u32 s62, s62, 43008
  s_cmp_eq_u32 s62, 1204224
  s_cselect_b32 s62, 0, s62
  s_add_u32 m0, s58, 4096
  s_nop 0
  buffer_load_dwordx4 v200, s[40:43], s62 offen lds
  s_add_u32 s62, s62, 43008
  s_cmp_eq_u32 s62, 1204224
  s_cselect_b32 s62, 0, s62
  s_waitcnt vmcnt(11)
  s_barrier
  s_add_u32 m0, s58, 5120
  s_nop 0
  buffer_load_dwordx4 v200, s[40:43], s62 offen lds
  s_add_u32 s62, s62, 43008
  s_cmp_eq_u32 s62, 1204224
  s_cselect_b32 s62, 0, s62
  s_add_u32 m0, s58, 6144
  s_nop 0
  buffer_load_dwordx4 v200, s[40:43], s62 offen lds
  s_add_u32 s62, s62, 43008
  s_cmp_eq_u32 s62, 1204224
  s_cselect_b32 s62, 0, s62
  buffer_load_dwordx2 v[252:253], v255, s[44:47], 0 offen sc1
  s_waitcnt vmcnt(5)
  s_barrier
  s_mov_b32 s3, 200000
  s_branch L_non_1_chk
L_non_1:
  buffer_load_dwordx2 v[252:253], v255, s[44:47], 0 offen sc1
L_non_1_chk:
  s_waitcnt vmcnt(0)
  v_readfirstlane_b32 s54, v252
  v_readfirstlane_b32 s55, v253
  s_sub_u32 s3, s3, 1
  s_cbranch_scc1 L_non_done_2
  s_cmp_eq_u32 s54, 0
  s_cbranch_scc1 L_non_1
L_non_done_2:
  ds_write_b16 v204, v202
  ds_write_b16 v205, v203
  s_waitcnt lgkmcnt(0)
  s_barrier
  s_cmp_lt_u32 s53, 8
  s_cbranch_scc0 L_wqa_later
  s_add_u32 m0, s58, 4294919168
  s_nop 0
  buffer_load_dwordx4 v200, s[28:31], s0 offen lds
  s_add_u32 s0, s0, 43008
  s_cmp_eq_u32 s0, 1204224
  s_cselect_b32 s0, 0, s0
  s_add_u32 m0, s58, 4294920192
  s_nop 0
  buffer_load_dwordx4 v200, s[28:31], s0 offen lds
  s_add_u32 s0, s0, 43008
  s_cmp_eq_u32 s0, 1204224
  s_cselect_b32 s0, 0, s0
  s_add_u32 m0, s58, 4294921216
  s_nop 0
  buffer_load_dwordx4 v200, s[28:31], s0 offen lds
  s_add_u32 s0, s0, 43008
  s_cmp_eq_u32 s0, 1204224
  s_cselect_b32 s0, 0, s0
  s_add_u32 m0, s58, 4294922240
  s_nop 0
  buffer_load_dwordx4 v200, s[28:31], s0 offen lds
  s_add_u32 s0, s0, 43008
  s_cmp_eq_u32 s0, 1204224
  s_cselect_b32 s0, 0, s0
  s_add_u32 m0, s58, 4294923264
  s_nop 0
  buffer_load_dwordx4 v200, s[28:31], s0 offen lds
  s_add_u32 s0, s0, 43008
  s_cmp_eq_u32 s0, 1204224
  s_cselect_b32 s0, 0, s0
  s_add_u32 m0, s58, 4294924288
  s_nop 0
  buffer_load_dwordx4 v200, s[28:31], s0 offen lds
  s_add_u32 s0, s0, 43008
  s_cmp_eq_u32 s0, 1204224
  s_cselect_b32 s0, 0, s0
  s_add_u32 m0, s58, 4294925312
  s_nop 0
  buffer_load_dwordx4 v200, s[28:31], s0 offen lds
  s_add_u32 s0, s0, 43008
  s_cmp_eq_u32 s0, 1204224
  s_cselect_b32 s0, 0, s0
L_wqa_later:
  s_mov_b32 s44, s6
  s_mov_b32 s45, s7
  s_mov_b32 s46, 1204224
  s_mov_b32 s47, 0x00020000
  s_mov_b32 s24, s22
  s_mov_b32 s25, s23
  s_mov_b32 s26, 12648448
  s_mov_b32 s27, 0x00020000
  s_lshl_b32 s64, s48, 18
  s_add_u32 s28, s22, s64
  s_addc_u32 s29, s23, 0
  s_mov_b32 s30, 262144
  s_mov_b32 s31, 0x00020000
  s_add_u32 s1, s64, 4194304
  s_lshl_b32 s65, s49, 2
  s_and_b32 s66, s52, 2
  s_add_u32 s58, s65, s66
  s_add_u32 s59, s65, s52
  s_lshl_b32 s64, s59, 5
  s_add_u32 s64, s64, s48
  s_lshl_b32 s64, s64, 11
  s_add_u32 s60, s64, 8388608
  s_lshl_b32 s64, s58, 5
  s_add_u32 s64, s64, s48
  s_lshl_b32 s64, s64, 1
  s_and_b32 s65, s52, 1
  s_add_u32 s64, s64, s65
  s_lshl_b32 s64, s64, 10
  s_add_u32 s61, s64, 8421376
  s_lshl_b32 s64, s49, 4
  s_add_u32 s64, s64, s48
  s_lshl_b32 s64, s64, 7
  s_add_u32 s62, s64, 12615680
  s_mov_b32 s32, s8
  s_mov_b32 s33, s9
  s_mov_b32 s34, 401408
  s_mov_b32 s35, 0x00020000
  s_mov_b32 s36, s14
  s_mov_b32 s37, s15
  s_mov_b32 s38, 401408
  s_mov_b32 s39, 0x00020000
  s_mov_b32 s40, s18
  s_mov_b32 s41, s19
  s_mov_b32 s42, 1835008
  s_mov_b32 s43, 0x00020000
  s_and_b32 s64, s2, 7
  s_lshl_b32 s64, s64, 2
  s_bfe_u32 s65, s2, 0x20003
  s_add_u32 s64, s64, s65
  s_lshr_b32 s63, s2, 5
  s_lshl_b32 s64, s64, 1
  s_add_u32 s66, s64, s51
  s_lshr_b32 s64, s66, 2
  s_lshl_b32 s64, s64, 11
  s_add_u32 s4, s64, 12615680
  s_lshl_b32 s64, s66, 16
  s_lshl_b32 s65, s52, 13
  s_add_u32 s64, s64, s65
  s_add_u32 s5, s64, 8388608
  s_mul_i32 s64, s66, 28672
  s_lshl_b32 s65, s63, 7
  s_add_u32 s64, s64, s65
  s_lshl_b32 s65, s52, 5
  s_add_u32 s6, s64, s65
  s_lshl_b32 s7, s52, 10
  s_mov_b32 s8, 0x5d800000
  s_and_b32 s9, s52, 1
  s_sub_u32 s9, s9, 1
  s_lshl_b32 s64, s53, 4
  s_add_u32 s64, s64, s49
  s_lshl_b32 s64, s64, 7
  s_add_u32 s19, s64, 12582912
  s_lshr_b32 s64, s48, 2
  s_lshl_b32 s64, s64, 11
  s_add_u32 s18, s64, 12582912
  v_lshrrev_b32 v15, 5, v0
  v_add_u32 v15, -1, v15
  v_mov_b32 v6, 0xdddddddd
  v_and_b32 v7, 31, v0
  v_mov_b32 v5, 1
  s_mul_i32 s65, s51, 24576
  s_add_u32 s65, s65, 114688
  v_add_u32 v245, s65, v1
  v_bfe_u32 v244, v0, 2, 2
  v_lshlrev_b32 v244, 7, v244
  v_bfe_u32 v10, v0, 4, 1
  v_lshl_add_u32 v244, v10, 5, v244
  v_and_b32 v10, 3, v0
  v_lshl_add_u32 v244, v10, 3, v244
  v_bfe_u32 v10, v0, 3, 1
  v_lshl_add_u32 v244, v10, 6, v244
  s_mul_i32 s65, s52, 14336
  s_add_u32 s65, s65, 58368
  v_add_u32 v242, s65, v244
  v_xor_b32 v243, 64, v242
  v_lshrrev_b32 v10, 5, v0
  v_lshl_add_u32 v240, v10, 9, v242
  v_lshl_add_u32 v241, v10, 9, v243
  v_mul_u32_u24 v244, 896, v7
  v_lshl_add_u32 v244, v10, 4, v244
  s_cmp_lg_u32 s52, 3
  s_cbranch_scc1 L_nomask
  v_lshrrev_b32 v10, 5, v0
  v_lshlrev_b32 v10, 2, v10
  v_sub_u32 v10, v7, v10
  v_mov_b32 v11, 0xff800000
  v_cmp_le_i32 s[66:67], 0, v10
  v_cmp_le_i32 s[10:11], 1, v10
  s_nop 0
  v_cndmask_b32 v128, v11, 0, s[66:67]
  v_cndmask_b32 v129, v11, 0, s[10:11]
  v_cmp_le_i32 s[66:67], 2, v10
  v_cmp_le_i32 s[10:11], 3, v10
  s_nop 0
  v_cndmask_b32 v130, v11, 0, s[66:67]
  v_cndmask_b32 v131, v11, 0, s[10:11]
  v_cmp_le_i32 s[66:67], 8, v10
  v_cmp_le_i32 s[10:11], 9, v10
  s_nop 0
  v_cndmask_b32 v132, v11, 0, s[66:67]
  v_cndmask_b32 v133, v11, 0, s[10:11]
  v_cmp_le_i32 s[66:67], 10, v10
  v_cmp_le_i32 s[10:11], 11, v10
  s_nop 0
  v_cndmask_b32 v134, v11, 0, s[66:67]
  v_cndmask_b32 v135, v11, 0, s[10:11]
  v_cmp_le_i32 s[66:67], 16, v10
  v_cmp_le_i32 s[10:11], 17, v10
  s_nop 0
  v_cndmask_b32 v136, v11, 0, s[66:67]
  v_cndmask_b32 v137, v11, 0, s[10:11]
  v_cmp_le_i32 s[66:67], 18, v10
  v_cmp_le_i32 s[10:11], 19, v10
  s_nop 0
  v_cndmask_b32 v138, v11, 0, s[66:67]
  v_cndmask_b32 v139, v11, 0, s[10:11]
  v_cmp_le_i32 s[66:67], 24, v10
  v_cmp_le_i32 s[10:11], 25, v10
  s_nop 0
  v_cndmask_b32 v140, v11, 0, s[66:67]
  v_cndmask_b32 v141, v11, 0, s[10:11]
  v_cmp_le_i32 s[66:67], 26, v10
  v_cmp_le_i32 s[10:11], 27, v10
  s_nop 0
  v_cndmask_b32 v142, v11, 0, s[66:67]
  v_cndmask_b32 v143, v11, 0, s[10:11]
  v_xor_b32 v112, v11, v128
  v_xor_b32 v113, v11, v129
  v_xor_b32 v114, v11, v130
  v_xor_b32 v115, v11, v131
  v_xor_b32 v116, v11, v132
  v_xor_b32 v117, v11, v133
  v_xor_b32 v118, v11, v134
  v_xor_b32 v119, v11, v135
  v_xor_b32 v120, v11, v136
  v_xor_b32 v121, v11, v137
  v_xor_b32 v122, v11, v138
  v_xor_b32 v123, v11, v139
  v_xor_b32 v124, v11, v140
  v_xor_b32 v125, v11, v141
  v_xor_b32 v126, v11, v142
  v_xor_b32 v127, v11, v143
  ds_write_b128 v1, v[112:115] offset:1024
  ds_write_b128 v1, v[116:119] offset:2048
  ds_write_b128 v1, v[120:123] offset:3072
  ds_write_b128 v1, v[124:127] offset:4096
  ds_write_b128 v1, v[128:131] offset:5120
  ds_write_b128 v1, v[132:135] offset:6144
  ds_write_b128 v1, v[136:139] offset:7168
  ds_write_b128 v1, v[140:143] offset:8192
  s_waitcnt lgkmcnt(0)
L_nomask:
  s_lshl_b32 s64, s52, 16
  s_add_u32 s64, s64, s1
  v_add_u32 v2, s64, v1
  s_lshl_b32 s64, s52, 12
  s_add_u32 s64, s64, 114688
  v_add_u32 v3, s64, v1
  v_and_b32 v10, 3, v0
  v_bfe_u32 v11, v0, 2, 1
  v_lshl_add_u32 v10, v11, 6, v10
  v_lshlrev_b32 v10, 7, v10
  s_lshl_b32 s67, s52, 9
  s_add_u32 s67, s67, s18
  s_add_u32 s67, s67, 16384
  v_add_u32 v11, 87040, v1
  s_mul_i32 s66, s52, 7168
  s_cmp_lt_u32 s53, 8
  s_barrier
  s_cbranch_scc1 L_wqa_done
  s_add_u32 m0, s66, 58368
  s_nop 0
  buffer_load_dwordx4 v200, s[44:47], s0 offen lds
  s_add_u32 s0, s0, 43008
  s_cmp_eq_u32 s0, 1204224
  s_cselect_b32 s0, 0, s0
  s_add_u32 m0, s66, 59392
  s_nop 0
  buffer_load_dwordx4 v200, s[44:47], s0 offen lds
  s_add_u32 s0, s0, 43008
  s_cmp_eq_u32 s0, 1204224
  s_cselect_b32 s0, 0, s0
  s_add_u32 m0, s66, 60416
  s_nop 0
  buffer_load_dwordx4 v200, s[44:47], s0 offen lds
  s_add_u32 s0, s0, 43008
  s_cmp_eq_u32 s0, 1204224
  s_cselect_b32 s0, 0, s0
  s_add_u32 m0, s66, 61440
  s_nop 0
  buffer_load_dwordx4 v200, s[44:47], s0 offen lds
  s_add_u32 s0, s0, 43008
  s_cmp_eq_u32 s0, 1204224
  s_cselect_b32 s0, 0, s0
  s_add_u32 m0, s66, 62464
  s_nop 0
  buffer_load_dwordx4 v200, s[44:47], s0 offen lds
  s_add_u32 s0, s0, 43008
  s_cmp_eq_u32 s0, 1204224
  s_cselect_b32 s0, 0, s0
  s_add_u32 m0, s66, 63488
  s_nop 0
  buffer_load_dwordx4 v200, s[44:47], s0 offen lds
  s_add_u32 s0, s0, 43008
  s_cmp_eq_u32 s0, 1204224
  s_cselect_b32 s0, 0, s0
  s_add_u32 m0, s66, 64512
  s_nop 0
  buffer_load_dwordx4 v200, s[44:47], s0 offen lds
  s_add_u32 s0, s0, 43008
  s_cmp_eq_u32 s0, 1204224
  s_cselect_b32 s0, 0, s0
L_wqa_done:
  v_mov_b32 v48, 0
  v_mov_b32 v49, 0
  v_mov_b32 v50, 0
  v_mov_b32 v51, 0
  v_mov_b32 v52, 0
  v_mov_b32 v53, 0
  v_mov_b32 v54, 0
  v_mov_b32 v55, 0
  v_mov_b32 v56, 0
  v_mov_b32 v57, 0
  v_mov_b32 v58, 0
  v_mov_b32 v59, 0
  v_mov_b32 v60, 0
  v_mov_b32 v61, 0
  v_mov_b32 v62, 0
  v_mov_b32 v63, 0
  v_mov_b32 v64, 0
  v_mov_b32 v65, 0
  v_mov_b32 v66, 0
  v_mov_b32 v67, 0
  v_mov_b32 v68, 0
  v_mov_b32 v69, 0
  v_mov_b32 v70, 0
  v_mov_b32 v71, 0
  v_mov_b32 v72, 0
  v_mov_b32 v73, 0
  v_mov_b32 v74, 0
  v_mov_b32 v75, 0
  v_mov_b32 v76, 0
  v_mov_b32 v77, 0
  v_mov_b32 v78, 0
  v_mov_b32 v79, 0
  v_mov_b32 v80, 0
  v_mov_b32 v81, 0
  v_mov_b32 v82, 0
  v_mov_b32 v83, 0
  v_mov_b32 v84, 0
  v_mov_b32 v85, 0
  v_mov_b32 v86, 0
  v_mov_b32 v87, 0
  v_mov_b32 v88, 0
  v_mov_b32 v89, 0
  v_mov_b32 v90, 0
  v_mov_b32 v91, 0
  v_mov_b32 v92, 0
  v_mov_b32 v93, 0
  v_mov_b32 v94, 0
  v_mov_b32 v95, 0
  v_mov_b32 v96, 0
  v_mov_b32 v97, 0
  v_mov_b32 v98, 0
  v_mov_b32 v99, 0
  v_mov_b32 v100, 0
  v_mov_b32 v101, 0
  v_mov_b32 v102, 0
  v_mov_b32 v103, 0
  v_mov_b32 v104, 0
  v_mov_b32 v105, 0
  v_mov_b32 v106, 0
  v_mov_b32 v107, 0
  v_mov_b32 v108, 0
  v_mov_b32 v109, 0
  v_mov_b32 v110, 0
  v_mov_b32 v111, 0
  s_setprio 2
  s_mov_b32 s3, 1600000
L_cw_3:
  ds_read_b32 v13, v255 offset:44
  s_waitcnt lgkmcnt(0)
  v_cmp_gt_u32 vcc, 4, v13
  s_cbranch_vccz L_cw_done_4
  s_sleep 1
  s_sub_u32 s3, s3, 1
  s_cbranch_scc0 L_cw_3
L_cw_done_4:
  ds_read_b128 v[16:19], v11 offset:0
  ds_read_b128 v[20:23], v11 offset:1024
  ds_read_b128 v[24:27], v11 offset:2048
  ds_read_b128 v[28:31], v11 offset:3072
  ds_read_b128 v[32:35], v11 offset:4096
  ds_read_b128 v[36:39], v11 offset:5120
  ds_read_b128 v[40:43], v11 offset:6144
  ds_read_b128 v[44:47], v11 offset:7168
  s_waitcnt vmcnt(2)
  buffer_load_dwordx2 v[12:13], v10, s[24:27], s67 offen sc1
  s_waitcnt vmcnt(1)
  s_mov_b64 exec, 1
  ds_add_u32 v255, v5 offset:40
  s_mov_b64 exec, -1
  s_waitcnt vmcnt(0)
  v_cmp_ne_u64 vcc, s[54:55], v[12:13]
  s_cbranch_vccz L_seen
  s_mov_b32 s3, 200000
L_poll_5:
  buffer_load_dwordx2 v[12:13], v10, s[24:27], s67 offen sc1
  s_waitcnt vmcnt(0)
  v_cmp_eq_u64 vcc, s[54:55], v[12:13]
  s_cmp_eq_u64 vcc, -1
  s_cbranch_scc1 L_poll_done_6
  s_sleep 4
  s_sub_u32 s3, s3, 1
  s_cbranch_scc0 L_poll_5
L_poll_done_6:
L_seen:
  s_mov_b32 s57, 0
  buffer_load_dwordx4 v[144:147], v2, s[24:27], s57 offen offset:0 sc1
  buffer_load_dwordx4 v[148:151], v2, s[24:27], s57 offen offset:1024 sc1
  buffer_load_dwordx4 v[152:155], v2, s[24:27], s57 offen offset:2048 sc1
  buffer_load_dwordx4 v[156:159], v2, s[24:27], s57 offen offset:3072 sc1
  s_mov_b32 s57, 4096
  buffer_load_dwordx4 v[160:163], v2, s[24:27], s57 offen offset:0 sc1
  buffer_load_dwordx4 v[164:167], v2, s[24:27], s57 offen offset:1024 sc1
  buffer_load_dwordx4 v[168:171], v2, s[24:27], s57 offen offset:2048 sc1
  buffer_load_dwordx4 v[172:175], v2, s[24:27], s57 offen offset:3072 sc1
  s_mov_b32 s57, 8192
  buffer_load_dwordx4 v[208:211], v2, s[24:27], s57 offen offset:0 sc1
  buffer_load_dwordx4 v[212:215], v2, s[24:27], s57 offen offset:1024 sc1
  buffer_load_dwordx4 v[216:219], v2, s[24:27], s57 offen offset:2048 sc1
  buffer_load_dwordx4 v[220:223], v2, s[24:27], s57 offen offset:3072 sc1
  s_mov_b32 s57, 12288
  buffer_load_dwordx4 v[224:227], v2, s[24:27], s57 offen offset:0 sc1
  buffer_load_dwordx4 v[228:231], v2, s[24:27], s57 offen offset:1024 sc1
  buffer_load_dwordx4 v[232:235], v2, s[24:27], s57 offen offset:2048 sc1
  buffer_load_dwordx4 v[236:239], v2, s[24:27], s57 offen offset:3072 sc1
  s_mov_b32 s57, 16384
  buffer_load_dwordx4 v[176:179], v2, s[24:27], s57 offen offset:0 sc1
  buffer_load_dwordx4 v[180:183], v2, s[24:27], s57 offen offset:1024 sc1
  buffer_load_dwordx4 v[184:187], v2, s[24:27], s57 offen offset:2048 sc1
  buffer_load_dwordx4 v[188:191], v2, s[24:27], s57 offen offset:3072 sc1
  s_mov_b64 exec, 1
  ds_add_u32 v255, v5 offset:4
  s_mov_b64 exec, -1
  s_branch L_main
L_compute:
  v_and_b32 v9, 15, v0
  v_lshrrev_b32 v10, 4, v0
  v_bfe_u32 v11, v0, 1, 3
  s_lshl_b32 s64, s52, 12
  v_lshlrev_b32 v12, 7, v9
  v_add_u32 v12, s64, v12
  v_xor_b32 v11, v11, v10
  v_lshl_add_u32 v242, v11, 4, v12
  v_xor_b32 v243, 64, v242
  v_xor_b32 v244, 4096, v242
  v_xor_b32 v245, 4096, v243
  v_add_u32 v242, 1024, v242
  v_add_u32 v243, 1024, v243
  v_add_u32 v244, 1024, v244
  v_add_u32 v245, 1024, v245
  v_lshlrev_b32 v240, 4, v9
  v_lshl_add_u32 v240, v10, 9, v240
  v_and_b32 v12, 3, v0
  v_lshlrev_b32 v12, 3, v12
  v_bfe_u32 v11, v0, 2, 3
  v_lshrrev_b32 v9, 5, v0
  v_lshl_add_u32 v11, v9, 4, v11
  s_and_b32 s64, s52, 1
  s_mul_i32 s64, s64, 112
  s_add_u32 s64, s64, 1024
  v_mul_u32_u24 v11, 224, v11
  v_add3_u32 v246, v11, v12, s64
  v_bfe_u32 v11, v0, 2, 2
  v_lshl_add_u32 v11, v10, 3, v11
  v_lshl_add_u32 v11, v11, 6, v12
  v_bfe_u32 v9, v0, 4, 1
  v_lshl_add_u32 v11, v9, 5, v11
  v_add_u32 v14, 106496, v11
  v_xor_b32 v9, 32, v14
  v_mov_b32 v241, 0
  s_mov_b32 exec_lo, 0x10001000
  s_mov_b32 exec_hi, 0x10001000
  v_mov_b32 v241, 0x3f803f80
  s_mov_b64 exec, -1
  s_waitcnt lgkmcnt(0)
  s_mov_b32 s44, s20
  s_mov_b32 s45, s21
  s_mov_b32 s46, 256
  s_mov_b32 s47, 0x00020000
  s_or_b32 s64, s2, s52
  s_cmp_lg_u32 s64, 0
  s_cbranch_scc1 L_notag
  s_memrealtime s[54:55]
  s_waitcnt lgkmcnt(0)
  s_or_b32 s54, s54, 1
  s_xor_b32 s55, s55, 0x5bd1e995
  v_mov_b32 v252, s54
  v_mov_b32 v253, s55
  s_mov_b64 exec, 1
  buffer_store_dwordx2 v[252:253], v255, s[44:47], 0 offen sc1
  s_mov_b64 exec, -1
L_notag:
  s_mov_b32 s24, s22
  s_mov_b32 s25, s23
  s_mov_b32 s26, 12648448
  s_mov_b32 s27, 0x00020000
  s_lshl_b32 s64, s48, 18
  s_add_u32 s28, s22, s64
  s_addc_u32 s29, s23, 0
  s_mov_b32 s30, 262144
  s_mov_b32 s31, 0x00020000
  s_add_u32 s1, s64, 4194304
  s_lshl_b32 s65, s49, 2
  s_and_b32 s66, s52, 2
  s_add_u32 s58, s65, s66
  s_add_u32 s59, s65, s52
  s_lshl_b32 s64, s59, 5
  s_add_u32 s64, s64, s48
  s_lshl_b32 s64, s64, 11
  s_add_u32 s60, s64, 8388608
  s_lshl_b32 s64, s58, 5
  s_add_u32 s64, s64, s48
  s_lshl_b32 s64, s64, 1
  s_and_b32 s65, s52, 1
  s_add_u32 s64, s64, s65
  s_lshl_b32 s64, s64, 10
  s_add_u32 s61, s64, 8421376
  s_lshl_b32 s64, s49, 4
  s_add_u32 s64, s64, s48
  s_lshl_b32 s64, s64, 7
  s_add_u32 s62, s64, 12615680
  s_mov_b32 s32, s8
  s_mov_b32 s33, s9
  s_mov_b32 s34, 401408
  s_mov_b32 s35, 0x00020000
  s_mov_b32 s36, s14
  s_mov_b32 s37, s15
  s_mov_b32 s38, 401408
  s_mov_b32 s39, 0x00020000
  s_mov_b32 s40, s18
  s_mov_b32 s41, s19
  s_mov_b32 s42, 1835008
  s_mov_b32 s43, 0x00020000
  s_and_b32 s64, s2, 7
  s_lshl_b32 s64, s64, 2
  s_bfe_u32 s65, s2, 0x20003
  s_add_u32 s64, s64, s65
  s_lshr_b32 s63, s2, 5
  s_lshl_b32 s64, s64, 1
  s_add_u32 s66, s64, s51
  s_lshr_b32 s64, s66, 2
  s_lshl_b32 s64, s64, 11
  s_add_u32 s4, s64, 12615680
  s_lshl_b32 s64, s66, 16
  s_lshl_b32 s65, s52, 13
  s_add_u32 s64, s64, s65
  s_add_u32 s5, s64, 8388608
  s_mul_i32 s64, s66, 28672
  s_lshl_b32 s65, s63, 7
  s_add_u32 s64, s64, s65
  s_lshl_b32 s65, s52, 5
  s_add_u32 s6, s64, s65
  s_lshl_b32 s7, s52, 10
  s_mov_b32 s8, 0x5d800000
  s_and_b32 s9, s52, 1
  s_sub_u32 s9, s9, 1
  s_lshl_b32 s64, s53, 4
  s_add_u32 s64, s64, s49
  s_lshl_b32 s64, s64, 7
  s_add_u32 s19, s64, 12582912
  s_lshr_b32 s64, s48, 2
  s_lshl_b32 s64, s64, 11
  s_add_u32 s18, s64, 12582912
  v_lshrrev_b32 v15, 5, v0
  v_add_u32 v15, -1, v15
  v_mov_b32 v6, 0xdddddddd
  v_and_b32 v7, 31, v0
  v_mov_b32 v5, 1
  v_lshrrev_b32 v10, 3, v0
  s_lshl_b32 s64, s52, 3
  v_add_u32 v10, s64, v10
  v_mul_u32_u24 v10, 896, v10
  v_bfe_u32 v11, v0, 4, 1
  v_lshlrev_b32 v11, 2, v11
  v_and_b32 v12, 7, v0
  v_xor_b32 v11, v11, v12
  v_lshl_add_u32 v10, v11, 4, v10
  s_min_u32 s64, s63, 6
  s_lshl_b32 s64, s64, 7
  v_add_u32 v254, s64, v10
  s_lshr_b32 s64, s53, 3
  s_lshl_b32 s64, s64, 2
  s_and_b32 s65, s53, 3
  s_add_u32 s64, s64, s65
  s_lshl_b32 s64, s64, 1
  s_and_b32 s65, s52, 1
  s_add_u32 s64, s64, s65
  s_lshl_b32 s64, s64, 7
  s_add_u32 s64, s64, s59
  s_lshl_b32 s10, s64, 12
  s_bitcmp1_b32 s53, 2
  s_cbranch_scc1 L_1a_V
L_1a_K:
  v_add_u32 v247, 16, v0
  v_lshrrev_b32 v247, 6, v247
  v_add_u32 v247, -1, v247
  s_xor_b32 s12, s10, 4096
  s_add_u32 s13, s10, 262144
  s_add_u32 s14, s12, 262144
  s_barrier
  ds_read_b128 v[16:19], v242 offset:0
  ds_read_b128 v[20:23], v242 offset:2048
  ds_read_b64_tr_b16 v[192:193], v246 offset:16384
  ds_read_b64_tr_b16 v[194:195], v246 offset:18176
  ds_read_b64_tr_b16 v[196:197], v246 offset:16416
  ds_read_b64_tr_b16 v[198:199], v246 offset:18208
  ds_read_b128 v[208:211], v244 offset:0
  ds_read_b128 v[212:215], v244 offset:2048
  ds_read_b64_tr_b16 v[200:201], v246 offset:16440
  ds_read_b64_tr_b16 v[202:203], v246 offset:18232
  ds_read_b64_tr_b16 v[204:205], v246 offset:16472
  ds_read_b64_tr_b16 v[206:207], v246 offset:18264
  s_waitcnt lgkmcnt(6)
  v_mfma_f32_16x16x32_bf16 v[128:131], v[192:195], v[16:19], 0
  ds_read_b128 v[24:27], v243 offset:0
  v_mfma_f32_16x16x32_bf16 v[132:135], v[196:199], v[16:19], 0
  ds_read_b128 v[28:31], v243 offset:2048
  v_mfma_f32_16x16x32_bf16 v[136:139], v[192:195], v[20:23], 0
  ds_read_b64_tr_b16 v[216:217], v246 offset:23552
  v_mfma_f32_16x16x32_bf16 v[140:143], v[196:199], v[20:23], 0
  ds_read_b64_tr_b16 v[218:219], v246 offset:25344
  s_waitcnt lgkmcnt(8)
  v_mfma_f32_16x16x32_bf16 v[144:147], v[192:195], v[208:211], 0
  ds_read_b64_tr_b16 v[220:221], v246 offset:23584
  v_mfma_f32_16x16x32_bf16 v[148:151], v[196:199], v[208:211], 0
  ds_read_b64_tr_b16 v[222:223], v246 offset:25376
  v_mfma_f32_16x16x32_bf16 v[152:155], v[192:195], v[212:215], 0
  ds_read_b128 v[232:235], v245 offset:0
  v_mfma_f32_16x16x32_bf16 v[156:159], v[196:199], v[212:215], 0
  ds_read_b128 v[236:239], v245 offset:2048
  s_waitcnt lgkmcnt(8)
  v_mfma_f32_16x16x32_bf16 v[160:163], v[200:203], v[16:19], 0
  ds_read_b64_tr_b16 v[224:225], v246 offset:23608
  v_mfma_f32_16x16x32_bf16 v[164:167], v[204:207], v[16:19], 0
  ds_read_b64_tr_b16 v[226:227], v246 offset:25400
  v_mfma_f32_16x16x32_bf16 v[168:171], v[200:203], v[20:23], 0
  ds_read_b64_tr_b16 v[228:229], v246 offset:23640
  v_mfma_f32_16x16x32_bf16 v[172:175], v[204:207], v[20:23], 0
  ds_read_b64_tr_b16 v[230:231], v246 offset:25432
  v_mfma_f32_16x16x32_bf16 v[176:179], v[200:203], v[208:211], 0
  v_mfma_f32_16x16x32_bf16 v[180:183], v[204:207], v[208:211], 0
  v_mfma_f32_16x16x32_bf16 v[184:187], v[200:203], v[212:215], 0
  v_mfma_f32_16x16x32_bf16 v[188:191], v[204:207], v[212:215], 0
  s_waitcnt lgkmcnt(6)
  v_mfma_f32_16x16x32_bf16 v[128:131], v[216:219], v[24:27], v[128:131]
  v_add_u32 v242, 30720, v242
  v_mfma_f32_16x16x32_bf16 v[132:135], v[220:223], v[24:27], v[132:135]
  v_add_u32 v243, 30720, v243
  v_mfma_f32_16x16x32_bf16 v[136:139], v[216:219], v[28:31], v[136:139]
  v_add_u32 v244, 30720, v244
  v_mfma_f32_16x16x32_bf16 v[140:143], v[220:223], v[28:31], v[140:143]
  v_add_u32 v245, 30720, v245
  v_add_u32 v246, 30720, v246
  s_waitcnt lgkmcnt(0)
  s_barrier
  v_mfma_f32_16x16x32_bf16 v[144:147], v[216:219], v[232:235], v[144:147]
  ds_read_b128 v[32:35], v242 offset:0
  v_mfma_f32_16x16x32_bf16 v[148:151], v[220:223], v[232:235], v[148:151]
  ds_read_b128 v[36:39], v242 offset:2048
  v_mfma_f32_16x16x32_bf16 v[152:155], v[216:219], v[236:239], v[152:155]
  ds_read_b64_tr_b16 v[192:193], v246 offset:16384
  v_mfma_f32_16x16x32_bf16 v[156:159], v[220:223], v[236:239], v[156:159]
  ds_read_b64_tr_b16 v[194:195], v246 offset:18176
  v_mfma_f32_16x16x32_bf16 v[160:163], v[224:227], v[24:27], v[160:163]
  ds_read_b64_tr_b16 v[196:197], v246 offset:16416
  v_mfma_f32_16x16x32_bf16 v[164:167], v[228:231], v[24:27], v[164:167]
  ds_read_b64_tr_b16 v[198:199], v246 offset:18208
  v_mfma_f32_16x16x32_bf16 v[168:171], v[224:227], v[28:31], v[168:171]
  ds_read_b128 v[208:211], v244 offset:0
  v_mfma_f32_16x16x32_bf16 v[172:175], v[228:231], v[28:31], v[172:175]
  ds_read_b128 v[212:215], v244 offset:2048
  v_mfma_f32_16x16x32_bf16 v[176:179], v[224:227], v[232:235], v[176:179]
  ds_read_b64_tr_b16 v[200:201], v246 offset:16440
  v_mfma_f32_16x16x32_bf16 v[180:183], v[228:231], v[232:235], v[180:183]
  ds_read_b64_tr_b16 v[202:203], v246 offset:18232
  v_mfma_f32_16x16x32_bf16 v[184:187], v[224:227], v[236:239], v[184:187]
  ds_read_b64_tr_b16 v[204:205], v246 offset:16472
  v_mfma_f32_16x16x32_bf16 v[188:191], v[228:231], v[236:239], v[188:191]
  ds_read_b64_tr_b16 v[206:207], v246 offset:18264
  s_waitcnt lgkmcnt(6)
  v_mfma_f32_16x16x32_bf16 v[128:131], v[192:195], v[32:35], v[128:131]
  ds_read_b128 v[40:43], v243 offset:0
  v_mfma_f32_16x16x32_bf16 v[132:135], v[196:199], v[32:35], v[132:135]
  ds_read_b128 v[44:47], v243 offset:2048
  v_mfma_f32_16x16x32_bf16 v[136:139], v[192:195], v[36:39], v[136:139]
  ds_read_b64_tr_b16 v[216:217], v246 offset:23552
  v_mfma_f32_16x16x32_bf16 v[140:143], v[196:199], v[36:39], v[140:143]
  ds_read_b64_tr_b16 v[218:219], v246 offset:25344
  s_waitcnt lgkmcnt(8)
  v_mfma_f32_16x16x32_bf16 v[144:147], v[192:195], v[208:211], v[144:147]
  ds_read_b64_tr_b16 v[220:221], v246 offset:23584
  v_mfma_f32_16x16x32_bf16 v[148:151], v[196:199], v[208:211], v[148:151]
  ds_read_b64_tr_b16 v[222:223], v246 offset:25376
  v_mfma_f32_16x16x32_bf16 v[152:155], v[192:195], v[212:215], v[152:155]
  ds_read_b128 v[232:235], v245 offset:0
  v_mfma_f32_16x16x32_bf16 v[156:159], v[196:199], v[212:215], v[156:159]
  ds_read_b128 v[236:239], v245 offset:2048
  s_waitcnt lgkmcnt(8)
  v_mfma_f32_16x16x32_bf16 v[160:163], v[200:203], v[32:35], v[160:163]
  ds_read_b64_tr_b16 v[224:225], v246 offset:23608
  v_mfma_f32_16x16x32_bf16 v[164:167], v[204:207], v[32:35], v[164:167]
  ds_read_b64_tr_b16 v[226:227], v246 offset:25400
  v_mfma_f32_16x16x32_bf16 v[168:171], v[200:203], v[36:39], v[168:171]
  ds_read_b64_tr_b16 v[228:229], v246 offset:23640
  v_mfma_f32_16x16x32_bf16 v[172:175], v[204:207], v[36:39], v[172:175]
  ds_read_b64_tr_b16 v[230:231], v246 offset:25432
  v_mfma_f32_16x16x32_bf16 v[176:179], v[200:203], v[208:211], v[176:179]
  v_mfma_f32_16x16x32_bf16 v[180:183], v[204:207], v[208:211], v[180:183]
  v_mfma_f32_16x16x32_bf16 v[184:187], v[200:203], v[212:215], v[184:187]
  v_mfma_f32_16x16x32_bf16 v[188:191], v[204:207], v[212:215], v[188:191]
  s_waitcnt lgkmcnt(6)
  v_mfma_f32_16x16x32_bf16 v[128:131], v[216:219], v[40:43], v[128:131]
  v_add_u32 v242, 30720, v242
  v_mfma_f32_16x16x32_bf16 v[132:135], v[220:223], v[40:43], v[132:135]
  v_add_u32 v243, 30720, v243
  v_mfma_f32_16x16x32_bf16 v[136:139], v[216:219], v[44:47], v[136:139]
  v_add_u32 v244, 30720, v244
  v_mfma_f32_16x16x32_bf16 v[140:143], v[220:223], v[44:47], v[140:143]
  v_add_u32 v245, 30720, v245
  v_add_u32 v246, 30720, v246
  s_waitcnt lgkmcnt(0)
  s_barrier
  v_mfma_f32_16x16x32_bf16 v[144:147], v[216:219], v[232:235], v[144:147]
  ds_read_b128 v[48:51], v242 offset:0
  v_mfma_f32_16x16x32_bf16 v[148:151], v[220:223], v[232:235], v[148:151]
  ds_read_b128 v[52:55], v242 offset:2048
  v_mfma_f32_16x16x32_bf16 v[152:155], v[216:219], v[236:239], v[152:155]
  ds_read_b64_tr_b16 v[192:193], v246 offset:16384
  v_mfma_f32_16x16x32_bf16 v[156:159], v[220:223], v[236:239], v[156:159]
  ds_read_b64_tr_b16 v[194:195], v246 offset:18176
  v_mfma_f32_16x16x32_bf16 v[160:163], v[224:227], v[40:43], v[160:163]
  ds_read_b64_tr_b16 v[196:197], v246 offset:16416
  v_mfma_f32_16x16x32_bf16 v[164:167], v[228:231], v[40:43], v[164:167]
  ds_read_b64_tr_b16 v[198:199], v246 offset:18208
  v_mfma_f32_16x16x32_bf16 v[168:171], v[224:227], v[44:47], v[168:171]
  ds_read_b128 v[208:211], v244 offset:0
  v_mfma_f32_16x16x32_bf16 v[172:175], v[228:231], v[44:47], v[172:175]
  ds_read_b128 v[212:215], v244 offset:2048
  v_mfma_f32_16x16x32_bf16 v[176:179], v[224:227], v[232:235], v[176:179]
  ds_read_b64_tr_b16 v[200:201], v246 offset:16440
  v_mfma_f32_16x16x32_bf16 v[180:183], v[228:231], v[232:235], v[180:183]
  ds_read_b64_tr_b16 v[202:203], v246 offset:18232
  v_mfma_f32_16x16x32_bf16 v[184:187], v[224:227], v[236:239], v[184:187]
  ds_read_b64_tr_b16 v[204:205], v246 offset:16472
  v_mfma_f32_16x16x32_bf16 v[188:191], v[228:231], v[236:239], v[188:191]
  ds_read_b64_tr_b16 v[206:207], v246 offset:18264
  s_waitcnt lgkmcnt(6)
  v_mfma_f32_16x16x32_bf16 v[128:131], v[192:195], v[48:51], v[128:131]
  ds_read_b128 v[56:59], v243 offset:0
  v_mfma_f32_16x16x32_bf16 v[132:135], v[196:199], v[48:51], v[132:135]
  ds_read_b128 v[60:63], v243 offset:2048
  v_mfma_f32_16x16x32_bf16 v[136:139], v[192:195], v[52:55], v[136:139]
  ds_read_b64_tr_b16 v[216:217], v246 offset:23552
  v_mfma_f32_16x16x32_bf16 v[140:143], v[196:199], v[52:55], v[140:143]
  ds_read_b64_tr_b16 v[218:219], v246 offset:25344
  s_waitcnt lgkmcnt(8)
  v_mfma_f32_16x16x32_bf16 v[144:147], v[192:195], v[208:211], v[144:147]
  ds_read_b64_tr_b16 v[220:221], v246 offset:23584
  v_mfma_f32_16x16x32_bf16 v[148:151], v[196:199], v[208:211], v[148:151]
  ds_read_b64_tr_b16 v[222:223], v246 offset:25376
  v_mfma_f32_16x16x32_bf16 v[152:155], v[192:195], v[212:215], v[152:155]
  ds_read_b128 v[232:235], v245 offset:0
  v_mfma_f32_16x16x32_bf16 v[156:159], v[196:199], v[212:215], v[156:159]
  ds_read_b128 v[236:239], v245 offset:2048
  s_waitcnt lgkmcnt(8)
  v_mfma_f32_16x16x32_bf16 v[160:163], v[200:203], v[48:51], v[160:163]
  ds_read_b64_tr_b16 v[224:225], v246 offset:23608
  v_mfma_f32_16x16x32_bf16 v[164:167], v[204:207], v[48:51], v[164:167]
  ds_read_b64_tr_b16 v[226:227], v246 offset:25400
  v_mfma_f32_16x16x32_bf16 v[168:171], v[200:203], v[52:55], v[168:171]
  ds_read_b64_tr_b16 v[228:229], v246 offset:23640
  v_mfma_f32_16x16x32_bf16 v[172:175], v[204:207], v[52:55], v[172:175]
  ds_read_b64_tr_b16 v[230:231], v246 offset:25432
  v_mfma_f32_16x16x32_bf16 v[176:179], v[200:203], v[208:211], v[176:179]
  v_mfma_f32_16x16x32_bf16 v[180:183], v[204:207], v[208:211], v[180:183]
  v_mfma_f32_16x16x32_bf16 v[184:187], v[200:203], v[212:215], v[184:187]
  v_mfma_f32_16x16x32_bf16 v[188:191], v[204:207], v[212:215], v[188:191]
  s_waitcnt lgkmcnt(6)
  v_mfma_f32_16x16x32_bf16 v[128:131], v[216:219], v[56:59], v[128:131]
  v_add_u32 v242, 4294905856, v242
  v_mfma_f32_16x16x32_bf16 v[132:135], v[220:223], v[56:59], v[132:135]
  v_add_u32 v243, 4294905856, v243
  v_mfma_f32_16x16x32_bf16 v[136:139], v[216:219], v[60:63], v[136:139]
  v_add_u32 v244, 4294905856, v244
  v_mfma_f32_16x16x32_bf16 v[140:143], v[220:223], v[60:63], v[140:143]
  v_add_u32 v245, 4294905856, v245
  v_add_u32 v246, 4294905856, v246
  s_waitcnt lgkmcnt(0)
  s_barrier
  v_mfma_f32_16x16x32_bf16 v[144:147], v[216:219], v[232:235], v[144:147]
  ds_read_b128 v[64:67], v242 offset:0
  v_mfma_f32_16x16x32_bf16 v[148:151], v[220:223], v[232:235], v[148:151]
  ds_read_b128 v[68:71], v242 offset:2048
  v_mfma_f32_16x16x32_bf16 v[152:155], v[216:219], v[236:239], v[152:155]
  ds_read_b64_tr_b16 v[192:193], v246 offset:16384
  v_mfma_f32_16x16x32_bf16 v[156:159], v[220:223], v[236:239], v[156:159]
  ds_read_b64_tr_b16 v[194:195], v246 offset:18176
  v_mfma_f32_16x16x32_bf16 v[160:163], v[224:227], v[56:59], v[160:163]
  ds_read_b64_tr_b16 v[196:197], v246 offset:16416
  v_mfma_f32_16x16x32_bf16 v[164:167], v[228:231], v[56:59], v[164:167]
  ds_read_b64_tr_b16 v[198:199], v246 offset:18208
  v_mfma_f32_16x16x32_bf16 v[168:171], v[224:227], v[60:63], v[168:171]
  ds_read_b128 v[208:211], v244 offset:0
  v_mfma_f32_16x16x32_bf16 v[172:175], v[228:231], v[60:63], v[172:175]
  ds_read_b128 v[212:215], v244 offset:2048
  v_mfma_f32_16x16x32_bf16 v[176:179], v[224:227], v[232:235], v[176:179]
  ds_read_b64_tr_b16 v[200:201], v246 offset:16440
  v_mfma_f32_16x16x32_bf16 v[180:183], v[228:231], v[232:235], v[180:183]
  ds_read_b64_tr_b16 v[202:203], v246 offset:18232
  v_mfma_f32_16x16x32_bf16 v[184:187], v[224:227], v[236:239], v[184:187]
  ds_read_b64_tr_b16 v[204:205], v246 offset:16472
  v_mfma_f32_16x16x32_bf16 v[188:191], v[228:231], v[236:239], v[188:191]
  ds_read_b64_tr_b16 v[206:207], v246 offset:18264
  s_waitcnt lgkmcnt(6)
  v_mfma_f32_16x16x32_bf16 v[128:131], v[192:195], v[64:67], v[128:131]
  ds_read_b128 v[72:75], v243 offset:0
  v_mfma_f32_16x16x32_bf16 v[132:135], v[196:199], v[64:67], v[132:135]
  ds_read_b128 v[76:79], v243 offset:2048
  v_mfma_f32_16x16x32_bf16 v[136:139], v[192:195], v[68:71], v[136:139]
  ds_read_b64_tr_b16 v[216:217], v246 offset:23552
  v_mfma_f32_16x16x32_bf16 v[140:143], v[196:199], v[68:71], v[140:143]
  ds_read_b64_tr_b16 v[218:219], v246 offset:25344
  s_waitcnt lgkmcnt(8)
  v_mfma_f32_16x16x32_bf16 v[144:147], v[192:195], v[208:211], v[144:147]
  ds_read_b64_tr_b16 v[220:221], v246 offset:23584
  v_mfma_f32_16x16x32_bf16 v[148:151], v[196:199], v[208:211], v[148:151]
  ds_read_b64_tr_b16 v[222:223], v246 offset:25376
  v_mfma_f32_16x16x32_bf16 v[152:155], v[192:195], v[212:215], v[152:155]
  ds_read_b128 v[232:235], v245 offset:0
  v_mfma_f32_16x16x32_bf16 v[156:159], v[196:199], v[212:215], v[156:159]
  ds_read_b128 v[236:239], v245 offset:2048
  s_waitcnt lgkmcnt(8)
  v_mfma_f32_16x16x32_bf16 v[160:163], v[200:203], v[64:67], v[160:163]
  ds_read_b64_tr_b16 v[224:225], v246 offset:23608
  v_mfma_f32_16x16x32_bf16 v[164:167], v[204:207], v[64:67], v[164:167]
  ds_read_b64_tr_b16 v[226:227], v246 offset:25400
  v_mfma_f32_16x16x32_bf16 v[168:171], v[200:203], v[68:71], v[168:171]
  ds_read_b64_tr_b16 v[228:229], v246 offset:23640
  v_mfma_f32_16x16x32_bf16 v[172:175], v[204:207], v[68:71], v[172:175]
  ds_read_b64_tr_b16 v[230:231], v246 offset:25432
  v_mfma_f32_16x16x32_bf16 v[176:179], v[200:203], v[208:211], v[176:179]
  v_mfma_f32_16x16x32_bf16 v[180:183], v[204:207], v[208:211], v[180:183]
  v_mfma_f32_16x16x32_bf16 v[184:187], v[200:203], v[212:215], v[184:187]
  v_mfma_f32_16x16x32_bf16 v[188:191], v[204:207], v[212:215], v[188:191]
  s_waitcnt lgkmcnt(6)
  v_mfma_f32_16x16x32_bf16 v[128:131], v[216:219], v[72:75], v[128:131]
  v_add_u32 v242, 30720, v242
  v_mfma_f32_16x16x32_bf16 v[132:135], v[220:223], v[72:75], v[132:135]
  v_add_u32 v243, 30720, v243
  v_mfma_f32_16x16x32_bf16 v[136:139], v[216:219], v[76:79], v[136:139]
  v_add_u32 v244, 30720, v244
  v_mfma_f32_16x16x32_bf16 v[140:143], v[220:223], v[76:79], v[140:143]
  v_add_u32 v245, 30720, v245
  v_add_u32 v246, 30720, v246
  s_waitcnt lgkmcnt(0)
  s_barrier
  buffer_load_dwordx2 v[252:253], v255, s[44:47], 0 offen sc1
  v_mfma_f32_16x16x32_bf16 v[144:147], v[216:219], v[232:235], v[144:147]
  ds_read_b128 v[80:83], v242 offset:0
  v_mfma_f32_16x16x32_bf16 v[148:151], v[220:223], v[232:235], v[148:151]
  ds_read_b128 v[84:87], v242 offset:2048
  v_mfma_f32_16x16x32_bf16 v[152:155], v[216:219], v[236:239], v[152:155]
  ds_read_b64_tr_b16 v[192:193], v246 offset:16384
  v_mfma_f32_16x16x32_bf16 v[156:159], v[220:223], v[236:239], v[156:159]
  ds_read_b64_tr_b16 v[194:195], v246 offset:18176
  v_mfma_f32_16x16x32_bf16 v[160:163], v[224:227], v[72:75], v[160:163]
  ds_read_b64_tr_b16 v[196:197], v246 offset:16416
  v_mfma_f32_16x16x32_bf16 v[164:167], v[228:231], v[72:75], v[164:167]
  ds_read_b64_tr_b16 v[198:199], v246 offset:18208
  v_mfma_f32_16x16x32_bf16 v[168:171], v[224:227], v[76:79], v[168:171]
  ds_read_b128 v[208:211], v244 offset:0
  v_mfma_f32_16x16x32_bf16 v[172:175], v[228:231], v[76:79], v[172:175]
  ds_read_b128 v[212:215], v244 offset:2048
  v_mfma_f32_16x16x32_bf16 v[176:179], v[224:227], v[232:235], v[176:179]
  ds_read_b64_tr_b16 v[200:201], v246 offset:16440
  v_mfma_f32_16x16x32_bf16 v[180:183], v[228:231], v[232:235], v[180:183]
  ds_read_b64_tr_b16 v[202:203], v246 offset:18232
  v_mfma_f32_16x16x32_bf16 v[184:187], v[224:227], v[236:239], v[184:187]
  ds_read_b64_tr_b16 v[204:205], v246 offset:16472
  v_mfma_f32_16x16x32_bf16 v[188:191], v[228:231], v[236:239], v[188:191]
  ds_read_b64_tr_b16 v[206:207], v246 offset:18264
  s_waitcnt lgkmcnt(6)
  v_mfma_f32_16x16x32_bf16 v[128:131], v[192:195], v[80:83], v[128:131]
  ds_read_b128 v[88:91], v243 offset:0
  v_mfma_f32_16x16x32_bf16 v[132:135], v[196:199], v[80:83], v[132:135]
  ds_read_b128 v[92:95], v243 offset:2048
  v_mfma_f32_16x16x32_bf16 v[136:139], v[192:195], v[84:87], v[136:139]
  ds_read_b64_tr_b16 v[216:217], v246 offset:23552
  v_mfma_f32_16x16x32_bf16 v[140:143], v[196:199], v[84:87], v[140:143]
  ds_read_b64_tr_b16 v[218:219], v246 offset:25344
  s_waitcnt lgkmcnt(8)
  v_mfma_f32_16x16x32_bf16 v[144:147], v[192:195], v[208:211], v[144:147]
  ds_read_b64_tr_b16 v[220:221], v246 offset:23584
  v_mfma_f32_16x16x32_bf16 v[148:151], v[196:199], v[208:211], v[148:151]
  ds_read_b64_tr_b16 v[222:223], v246 offset:25376
  v_mfma_f32_16x16x32_bf16 v[152:155], v[192:195], v[212:215], v[152:155]
  ds_read_b128 v[232:235], v245 offset:0
  v_mfma_f32_16x16x32_bf16 v[156:159], v[196:199], v[212:215], v[156:159]
  ds_read_b128 v[236:239], v245 offset:2048
  s_waitcnt lgkmcnt(8)
  v_mfma_f32_16x16x32_bf16 v[160:163], v[200:203], v[80:83], v[160:163]
  ds_read_b64_tr_b16 v[224:225], v246 offset:23608
  v_mfma_f32_16x16x32_bf16 v[164:167], v[204:207], v[80:83], v[164:167]
  ds_read_b64_tr_b16 v[226:227], v246 offset:25400
  v_mfma_f32_16x16x32_bf16 v[168:171], v[200:203], v[84:87], v[168:171]
  ds_read_b64_tr_b16 v[228:229], v246 offset:23640
  v_mfma_f32_16x16x32_bf16 v[172:175], v[204:207], v[84:87], v[172:175]
  ds_read_b64_tr_b16 v[230:231], v246 offset:25432
  v_mfma_f32_16x16x32_bf16 v[176:179], v[200:203], v[208:211], v[176:179]
  v_mfma_f32_16x16x32_bf16 v[180:183], v[204:207], v[208:211], v[180:183]
  v_mfma_f32_16x16x32_bf16 v[184:187], v[200:203], v[212:215], v[184:187]
  v_mfma_f32_16x16x32_bf16 v[188:191], v[204:207], v[212:215], v[188:191]
  s_waitcnt lgkmcnt(6)
  v_mfma_f32_16x16x32_bf16 v[128:131], v[216:219], v[88:91], v[128:131]
  v_add_u32 v242, 30720, v242
  v_mfma_f32_16x16x32_bf16 v[132:135], v[220:223], v[88:91], v[132:135]
  v_add_u32 v243, 30720, v243
  v_mfma_f32_16x16x32_bf16 v[136:139], v[216:219], v[92:95], v[136:139]
  v_add_u32 v244, 30720, v244
  v_mfma_f32_16x16x32_bf16 v[140:143], v[220:223], v[92:95], v[140:143]
  v_add_u32 v245, 30720, v245
  v_add_u32 v246, 30720, v246
  s_waitcnt lgkmcnt(0)
  s_barrier
  v_mfma_f32_16x16x32_bf16 v[144:147], v[216:219], v[232:235], v[144:147]
  ds_read_b128 v[96:99], v242 offset:0
  v_mfma_f32_16x16x32_bf16 v[148:151], v[220:223], v[232:235], v[148:151]
  ds_read_b128 v[100:103], v242 offset:2048
  v_mfma_f32_16x16x32_bf16 v[152:155], v[216:219], v[236:239], v[152:155]
  ds_read_b64_tr_b16 v[192:193], v246 offset:16384
  v_mfma_f32_16x16x32_bf16 v[156:159], v[220:223], v[236:239], v[156:159]
  ds_read_b64_tr_b16 v[194:195], v246 offset:18176
  v_mfma_f32_16x16x32_bf16 v[160:163], v[224:227], v[88:91], v[160:163]
  ds_read_b64_tr_b16 v[196:197], v246 offset:16416
  v_mfma_f32_16x16x32_bf16 v[164:167], v[228:231], v[88:91], v[164:167]
  ds_read_b64_tr_b16 v[198:199], v246 offset:18208
  v_mfma_f32_16x16x32_bf16 v[168:171], v[224:227], v[92:95], v[168:171]
  ds_read_b128 v[208:211], v244 offset:0
  v_mfma_f32_16x16x32_bf16 v[172:175], v[228:231], v[92:95], v[172:175]
  ds_read_b128 v[212:215], v244 offset:2048
  v_mfma_f32_16x16x32_bf16 v[176:179], v[224:227], v[232:235], v[176:179]
  ds_read_b64_tr_b16 v[200:201], v246 offset:16440
  v_mfma_f32_16x16x32_bf16 v[180:183], v[228:231], v[232:235], v[180:183]
  ds_read_b64_tr_b16 v[202:203], v246 offset:18232
  v_mfma_f32_16x16x32_bf16 v[184:187], v[224:227], v[236:239], v[184:187]
  ds_read_b64_tr_b16 v[204:205], v246 offset:16472
  v_mfma_f32_16x16x32_bf16 v[188:191], v[228:231], v[236:239], v[188:191]
  ds_read_b64_tr_b16 v[206:207], v246 offset:18264
  s_waitcnt lgkmcnt(6)
  v_mfma_f32_16x16x32_bf16 v[128:131], v[192:195], v[96:99], v[128:131]
  ds_read_b128 v[104:107], v243 offset:0
  v_mfma_f32_16x16x32_bf16 v[132:135], v[196:199], v[96:99], v[132:135]
  ds_read_b128 v[108:111], v243 offset:2048
  v_mfma_f32_16x16x32_bf16 v[136:139], v[192:195], v[100:103], v[136:139]
  ds_read_b64_tr_b16 v[216:217], v246 offset:23552
  v_mfma_f32_16x16x32_bf16 v[140:143], v[196:199], v[100:103], v[140:143]
  ds_read_b64_tr_b16 v[218:219], v246 offset:25344
  s_waitcnt lgkmcnt(8)
  v_mfma_f32_16x16x32_bf16 v[144:147], v[192:195], v[208:211], v[144:147]
  ds_read_b64_tr_b16 v[220:221], v246 offset:23584
  v_mfma_f32_16x16x32_bf16 v[148:151], v[196:199], v[208:211], v[148:151]
  ds_read_b64_tr_b16 v[222:223], v246 offset:25376
  v_mfma_f32_16x16x32_bf16 v[152:155], v[192:195], v[212:215], v[152:155]
  ds_read_b128 v[232:235], v245 offset:0
  v_mfma_f32_16x16x32_bf16 v[156:159], v[196:199], v[212:215], v[156:159]
  ds_read_b128 v[236:239], v245 offset:2048
  s_waitcnt lgkmcnt(8)
  v_mfma_f32_16x16x32_bf16 v[160:163], v[200:203], v[96:99], v[160:163]
  ds_read_b64_tr_b16 v[224:225], v246 offset:23608
  v_mfma_f32_16x16x32_bf16 v[164:167], v[204:207], v[96:99], v[164:167]
  ds_read_b64_tr_b16 v[226:227], v246 offset:25400
  v_mfma_f32_16x16x32_bf16 v[168:171], v[200:203], v[100:103], v[168:171]
  ds_read_b64_tr_b16 v[228:229], v246 offset:23640
  v_mfma_f32_16x16x32_bf16 v[172:175], v[204:207], v[100:103], v[172:175]
  ds_read_b64_tr_b16 v[230:231], v246 offset:25432
  v_mfma_f32_16x16x32_bf16 v[176:179], v[200:203], v[208:211], v[176:179]
  v_mfma_f32_16x16x32_bf16 v[180:183], v[204:207], v[208:211], v[180:183]
  v_mfma_f32_16x16x32_bf16 v[184:187], v[200:203], v[212:215], v[184:187]
  v_mfma_f32_16x16x32_bf16 v[188:191], v[204:207], v[212:215], v[188:191]
  s_waitcnt lgkmcnt(6)
  v_mfma_f32_16x16x32_bf16 v[128:131], v[216:219], v[104:107], v[128:131]
  v_add_u32 v242, 4294905856, v242
  v_mfma_f32_16x16x32_bf16 v[132:135], v[220:223], v[104:107], v[132:135]
  v_add_u32 v243, 4294905856, v243
  v_mfma_f32_16x16x32_bf16 v[136:139], v[216:219], v[108:111], v[136:139]
  v_add_u32 v244, 4294905856, v244
  v_mfma_f32_16x16x32_bf16 v[140:143], v[220:223], v[108:111], v[140:143]
  v_add_u32 v245, 4294905856, v245
  v_add_u32 v246, 4294905856, v246
  s_waitcnt lgkmcnt(4)
  v_mfma_f32_16x16x32_bf16 v[144:147], v[216:219], v[232:235], v[144:147]
  v_mfma_f32_16x16x32_bf16 v[148:151], v[220:223], v[232:235], v[148:151]
  v_mfma_f32_16x16x32_bf16 v[152:155], v[216:219], v[236:239], v[152:155]
  v_mfma_f32_16x16x32_bf16 v[156:159], v[220:223], v[236:239], v[156:159]
  s_waitcnt lgkmcnt(0)
  s_mov_b32 s3, 200000
  s_branch L_non_7_chk
L_non_7:
  buffer_load_dwordx2 v[252:253], v255, s[44:47], 0 offen sc1
L_non_7_chk:
  s_waitcnt vmcnt(0)
  v_readfirstlane_b32 s54, v252
  v_readfirstlane_b32 s55, v253
  s_sub_u32 s3, s3, 1
  s_cbranch_scc1 L_non_done_8
  s_cmp_eq_u32 s54, 0
  s_cbranch_scc1 L_non_7
L_non_done_8:
  s_barrier
  v_mfma_f32_16x16x32_bf16 v[160:163], v[224:227], v[104:107], v[160:163]
  ds_read_b128 v[112:115], v242 offset:0
  ds_read_b128 v[116:119], v242 offset:2048
  v_mfma_f32_16x16x32_bf16 v[164:167], v[228:231], v[104:107], v[164:167]
  ds_read_b64_tr_b16 v[192:193], v246 offset:16384
  ds_read_b64_tr_b16 v[194:195], v246 offset:18176
  v_mfma_f32_16x16x32_bf16 v[168:171], v[224:227], v[108:111], v[168:171]
  ds_read_b64_tr_b16 v[196:197], v246 offset:16416
  ds_read_b64_tr_b16 v[198:199], v246 offset:18208
  v_mfma_f32_16x16x32_bf16 v[172:175], v[228:231], v[108:111], v[172:175]
  ds_read_b128 v[120:123], v243 offset:0
  ds_read_b128 v[124:127], v243 offset:2048
  v_mfma_f32_16x16x32_bf16 v[176:179], v[224:227], v[232:235], v[176:179]
  ds_read_b64_tr_b16 v[216:217], v246 offset:23552
  ds_read_b64_tr_b16 v[218:219], v246 offset:25344
  v_mfma_f32_16x16x32_bf16 v[180:183], v[228:231], v[232:235], v[180:183]
  ds_read_b64_tr_b16 v[220:221], v246 offset:23584
  ds_read_b64_tr_b16 v[222:223], v246 offset:25376
  v_mfma_f32_16x16x32_bf16 v[184:187], v[224:227], v[236:239], v[184:187]
  ds_read_b128 v[208:211], v244 offset:0
  ds_read_b128 v[212:215], v244 offset:2048
  v_mfma_f32_16x16x32_bf16 v[188:191], v[228:231], v[236:239], v[188:191]
  s_cmp_lt_u32 s53, 8
  s_waitcnt lgkmcnt(8)
  v_mfma_f32_16x16x32_bf16 v[128:131], v[192:195], v[112:115], v[128:131]
  ds_read_b128 v[232:235], v245 offset:0
  ds_read_b128 v[236:239], v245 offset:2048
  v_mfma_f32_16x16x32_bf16 v[132:135], v[196:199], v[112:115], v[132:135]
  ds_read_b64_tr_b16 v[200:201], v246 offset:16440
  ds_read_b64_tr_b16 v[202:203], v246 offset:18232
  v_mfma_f32_16x16x32_bf16 v[136:139], v[192:195], v[116:119], v[136:139]
  ds_read_b64_tr_b16 v[204:205], v246 offset:16472
  ds_read_b64_tr_b16 v[206:207], v246 offset:18264
  v_mfma_f32_16x16x32_bf16 v[140:143], v[196:199], v[116:119], v[140:143]
  ds_read_b64_tr_b16 v[224:225], v246 offset:23608
  ds_read_b64_tr_b16 v[226:227], v246 offset:25400
  s_waitcnt lgkmcnt(10)
  v_mfma_f32_16x16x32_bf16 v[128:131], v[216:219], v[120:123], v[128:131]
  ds_read_b64_tr_b16 v[228:229], v246 offset:23640
  ds_read_b64_tr_b16 v[230:231], v246 offset:25432
  v_mfma_f32_16x16x32_bf16 v[132:135], v[220:223], v[120:123], v[132:135]
  v_mfma_f32_16x16x32_bf16 v[136:139], v[216:219], v[124:127], v[136:139]
  v_mfma_f32_16x16x32_bf16 v[140:143], v[220:223], v[124:127], v[140:143]
  s_waitcnt lgkmcnt(10)
  v_mfma_f32_16x16x32_bf16 v[144:147], v[192:195], v[208:211], v[144:147]
  v_mfma_f32_16x16x32_bf16 v[148:151], v[196:199], v[208:211], v[148:151]
  v_mfma_f32_16x16x32_bf16 v[152:155], v[192:195], v[212:215], v[152:155]
  v_mfma_f32_16x16x32_bf16 v[156:159], v[196:199], v[212:215], v[156:159]
  s_waitcnt lgkmcnt(8)
  v_mfma_f32_16x16x32_bf16 v[144:147], v[216:219], v[232:235], v[144:147]
  v_mfma_f32_16x16x32_bf16 v[148:151], v[220:223], v[232:235], v[148:151]
  v_cvt_pk_bf16_f32 v248, v128, v129
  v_cvt_pk_bf16_f32 v249, v130, v131
  v_mfma_f32_16x16x32_bf16 v[152:155], v[216:219], v[236:239], v[152:155]
  v_cvt_pk_bf16_f32 v250, v132, v133
  v_cvt_pk_bf16_f32 v251, v134, v135
  v_mfma_f32_16x16x32_bf16 v[156:159], v[220:223], v[236:239], v[156:159]
  v_cvt_pk_bf16_f32 v242, v136, v137
  v_cvt_pk_bf16_f32 v243, v138, v139
  s_waitcnt lgkmcnt(4)
  v_mfma_f32_16x16x32_bf16 v[160:163], v[200:203], v[112:115], v[160:163]
  v_cvt_pk_bf16_f32 v244, v140, v141
  v_cvt_pk_bf16_f32 v245, v142, v143
  v_mfma_f32_16x16x32_bf16 v[164:167], v[204:207], v[112:115], v[164:167]
  v_and_b32 v250, v247, v250
  v_and_b32 v251, v247, v251
  v_mfma_f32_16x16x32_bf16 v[168:171], v[200:203], v[116:119], v[168:171]
  v_and_b32 v244, v247, v244
  v_and_b32 v245, v247, v245
  v_mfma_f32_16x16x32_bf16 v[172:175], v[204:207], v[116:119], v[172:175]
  s_cbranch_scc1 L_nost_9
  buffer_store_dwordx4 v[248:251], v240, s[24:27], s10 offen sc1
  buffer_store_dwordx4 v[242:245], v240, s[24:27], s10 offen offset:256 sc1
L_nost_9:
  s_waitcnt lgkmcnt(0)
  v_mfma_f32_16x16x32_bf16 v[160:163], v[224:227], v[120:123], v[160:163]
  v_mfma_f32_16x16x32_bf16 v[164:167], v[228:231], v[120:123], v[164:167]
  v_cvt_pk_bf16_f32 v192, v144, v145
  v_cvt_pk_bf16_f32 v193, v146, v147
  v_mfma_f32_16x16x32_bf16 v[168:171], v[224:227], v[124:127], v[168:171]
  v_cvt_pk_bf16_f32 v194, v148, v149
  v_cvt_pk_bf16_f32 v195, v150, v151
  v_mfma_f32_16x16x32_bf16 v[172:175], v[228:231], v[124:127], v[172:175]
  v_cvt_pk_bf16_f32 v196, v152, v153
  v_cvt_pk_bf16_f32 v197, v154, v155
  v_mfma_f32_16x16x32_bf16 v[176:179], v[200:203], v[208:211], v[176:179]
  v_cvt_pk_bf16_f32 v198, v156, v157
  v_cvt_pk_bf16_f32 v199, v158, v159
  v_mfma_f32_16x16x32_bf16 v[180:183], v[204:207], v[208:211], v[180:183]
  v_and_b32 v194, v247, v194
  v_and_b32 v195, v247, v195
  v_mfma_f32_16x16x32_bf16 v[184:187], v[200:203], v[212:215], v[184:187]
  v_and_b32 v198, v247, v198
  v_and_b32 v199, v247, v199
  v_mfma_f32_16x16x32_bf16 v[188:191], v[204:207], v[212:215], v[188:191]
  s_cbranch_scc1 L_nost_10
  buffer_store_dwordx4 v[192:195], v240, s[24:27], s12 offen sc1
  buffer_store_dwordx4 v[196:199], v240, s[24:27], s12 offen offset:256 sc1
L_nost_10:
  v_mfma_f32_16x16x32_bf16 v[176:179], v[224:227], v[232:235], v[176:179]
  v_mfma_f32_16x16x32_bf16 v[180:183], v[228:231], v[232:235], v[180:183]
  v_cvt_pk_bf16_f32 v216, v160, v161
  v_cvt_pk_bf16_f32 v217, v162, v163
  v_mfma_f32_16x16x32_bf16 v[184:187], v[224:227], v[236:239], v[184:187]
  v_cvt_pk_bf16_f32 v218, v164, v165
  v_cvt_pk_bf16_f32 v219, v166, v167
  v_mfma_f32_16x16x32_bf16 v[188:191], v[228:231], v[236:239], v[188:191]
  v_cvt_pk_bf16_f32 v220, v168, v169
  v_cvt_pk_bf16_f32 v221, v170, v171
  v_cvt_pk_bf16_f32 v222, v172, v173
  v_cvt_pk_bf16_f32 v223, v174, v175
  v_and_b32 v218, v247, v218
  v_and_b32 v219, v247, v219
  v_and_b32 v222, v247, v222
  v_and_b32 v223, v247, v223
  s_cbranch_scc1 L_nost_11
  buffer_store_dwordx4 v[216:219], v240, s[24:27], s13 offen sc1
  buffer_store_dwordx4 v[220:223], v240, s[24:27], s13 offen offset:256 sc1
L_nost_11:
  s_nop 0
  v_cvt_pk_bf16_f32 v200, v176, v177
  v_cvt_pk_bf16_f32 v201, v178, v179
  v_cvt_pk_bf16_f32 v202, v180, v181
  v_cvt_pk_bf16_f32 v203, v182, v183
  v_cvt_pk_bf16_f32 v204, v184, v185
  v_cvt_pk_bf16_f32 v205, v186, v187
  v_cvt_pk_bf16_f32 v206, v188, v189
  v_cvt_pk_bf16_f32 v207, v190, v191
  v_and_b32 v202, v247, v202
  v_and_b32 v203, v247, v203
  v_and_b32 v206, v247, v206
  v_and_b32 v207, v247, v207
  s_cbranch_scc1 L_nost_12
  buffer_store_dwordx4 v[200:203], v240, s[24:27], s14 offen sc1
  buffer_store_dwordx4 v[204:207], v240, s[24:27], s14 offen offset:256 sc1
L_nost_12:
  s_branch L_1a_join
L_1a_V:
  s_add_u32 s10, s10, 2048
  v_bfe_u32 v247, v0, 2, 2
  v_add_u32 v247, 1, v247
  v_lshrrev_b32 v247, 2, v247
  v_add_u32 v247, -1, v247
  s_xor_b32 s12, s10, 4096
  s_add_u32 s13, s10, 262144
  s_add_u32 s14, s12, 262144
  s_barrier
  ds_read_b128 v[16:19], v242 offset:0
  ds_read_b128 v[20:23], v242 offset:2048
  ds_read_b64_tr_b16 v[192:193], v246 offset:16384
  ds_read_b64_tr_b16 v[194:195], v246 offset:18176
  ds_read_b64_tr_b16 v[196:197], v246 offset:16416
  ds_read_b64_tr_b16 v[198:199], v246 offset:18208
  ds_read_b128 v[208:211], v244 offset:0
  ds_read_b128 v[212:215], v244 offset:2048
  ds_read_b64_tr_b16 v[200:201], v246 offset:16440
  ds_read_b64_tr_b16 v[202:203], v246 offset:18232
  ds_read_b64_tr_b16 v[204:205], v246 offset:16472
  ds_read_b64_tr_b16 v[206:207], v246 offset:18264
  s_waitcnt lgkmcnt(6)
  v_mfma_f32_16x16x32_bf16 v[128:131], v[16:19], v[192:195], 0
  ds_read_b128 v[24:27], v243 offset:0
  v_mfma_f32_16x16x32_bf16 v[132:135], v[20:23], v[192:195], 0
  ds_read_b128 v[28:31], v243 offset:2048
  v_mfma_f32_16x16x32_bf16 v[136:139], v[16:19], v[196:199], 0
  ds_read_b64_tr_b16 v[216:217], v246 offset:23552
  v_mfma_f32_16x16x32_bf16 v[140:143], v[20:23], v[196:199], 0
  ds_read_b64_tr_b16 v[218:219], v246 offset:25344
  s_waitcnt lgkmcnt(8)
  v_mfma_f32_16x16x32_bf16 v[144:147], v[208:211], v[192:195], 0
  ds_read_b64_tr_b16 v[220:221], v246 offset:23584
  v_mfma_f32_16x16x32_bf16 v[148:151], v[212:215], v[192:195], 0
  ds_read_b64_tr_b16 v[222:223], v246 offset:25376
  v_mfma_f32_16x16x32_bf16 v[152:155], v[208:211], v[196:199], 0
  ds_read_b128 v[232:235], v245 offset:0
  v_mfma_f32_16x16x32_bf16 v[156:159], v[212:215], v[196:199], 0
  ds_read_b128 v[236:239], v245 offset:2048
  s_waitcnt lgkmcnt(8)
  v_mfma_f32_16x16x32_bf16 v[160:163], v[16:19], v[200:203], 0
  ds_read_b64_tr_b16 v[224:225], v246 offset:23608
  v_mfma_f32_16x16x32_bf16 v[164:167], v[20:23], v[200:203], 0
  ds_read_b64_tr_b16 v[226:227], v246 offset:25400
  v_mfma_f32_16x16x32_bf16 v[168:171], v[16:19], v[204:207], 0
  ds_read_b64_tr_b16 v[228:229], v246 offset:23640
  v_mfma_f32_16x16x32_bf16 v[172:175], v[20:23], v[204:207], 0
  ds_read_b64_tr_b16 v[230:231], v246 offset:25432
  v_mfma_f32_16x16x32_bf16 v[176:179], v[208:211], v[200:203], 0
  v_mfma_f32_16x16x32_bf16 v[180:183], v[212:215], v[200:203], 0
  v_mfma_f32_16x16x32_bf16 v[184:187], v[208:211], v[204:207], 0
  v_mfma_f32_16x16x32_bf16 v[188:191], v[212:215], v[204:207], 0
  s_waitcnt lgkmcnt(6)
  v_mfma_f32_16x16x32_bf16 v[128:131], v[24:27], v[216:219], v[128:131]
  v_add_u32 v242, 30720, v242
  v_mfma_f32_16x16x32_bf16 v[132:135], v[28:31], v[216:219], v[132:135]
  v_add_u32 v243, 30720, v243
  v_mfma_f32_16x16x32_bf16 v[136:139], v[24:27], v[220:223], v[136:139]
  v_add_u32 v244, 30720, v244
  v_mfma_f32_16x16x32_bf16 v[140:143], v[28:31], v[220:223], v[140:143]
  v_add_u32 v245, 30720, v245
  v_add_u32 v246, 30720, v246
  s_waitcnt lgkmcnt(0)
  s_barrier
  v_mfma_f32_16x16x32_bf16 v[144:147], v[232:235], v[216:219], v[144:147]
  ds_read_b128 v[32:35], v242 offset:0
  v_mfma_f32_16x16x32_bf16 v[148:151], v[236:239], v[216:219], v[148:151]
  ds_read_b128 v[36:39], v242 offset:2048
  v_mfma_f32_16x16x32_bf16 v[152:155], v[232:235], v[220:223], v[152:155]
  ds_read_b64_tr_b16 v[192:193], v246 offset:16384
  v_mfma_f32_16x16x32_bf16 v[156:159], v[236:239], v[220:223], v[156:159]
  ds_read_b64_tr_b16 v[194:195], v246 offset:18176
  v_mfma_f32_16x16x32_bf16 v[160:163], v[24:27], v[224:227], v[160:163]
  ds_read_b64_tr_b16 v[196:197], v246 offset:16416
  v_mfma_f32_16x16x32_bf16 v[164:167], v[28:31], v[224:227], v[164:167]
  ds_read_b64_tr_b16 v[198:199], v246 offset:18208
  v_mfma_f32_16x16x32_bf16 v[168:171], v[24:27], v[228:231], v[168:171]
  ds_read_b128 v[208:211], v244 offset:0
  v_mfma_f32_16x16x32_bf16 v[172:175], v[28:31], v[228:231], v[172:175]
  ds_read_b128 v[212:215], v244 offset:2048
  v_mfma_f32_16x16x32_bf16 v[176:179], v[232:235], v[224:227], v[176:179]
  ds_read_b64_tr_b16 v[200:201], v246 offset:16440
  v_mfma_f32_16x16x32_bf16 v[180:183], v[236:239], v[224:227], v[180:183]
  ds_read_b64_tr_b16 v[202:203], v246 offset:18232
  v_mfma_f32_16x16x32_bf16 v[184:187], v[232:235], v[228:231], v[184:187]
  ds_read_b64_tr_b16 v[204:205], v246 offset:16472
  v_mfma_f32_16x16x32_bf16 v[188:191], v[236:239], v[228:231], v[188:191]
  ds_read_b64_tr_b16 v[206:207], v246 offset:18264
  s_waitcnt lgkmcnt(6)
  v_mfma_f32_16x16x32_bf16 v[128:131], v[32:35], v[192:195], v[128:131]
  ds_read_b128 v[40:43], v243 offset:0
  v_mfma_f32_16x16x32_bf16 v[132:135], v[36:39], v[192:195], v[132:135]
  ds_read_b128 v[44:47], v243 offset:2048
  v_mfma_f32_16x16x32_bf16 v[136:139], v[32:35], v[196:199], v[136:139]
  ds_read_b64_tr_b16 v[216:217], v246 offset:23552
  v_mfma_f32_16x16x32_bf16 v[140:143], v[36:39], v[196:199], v[140:143]
  ds_read_b64_tr_b16 v[218:219], v246 offset:25344
  s_waitcnt lgkmcnt(8)
  v_mfma_f32_16x16x32_bf16 v[144:147], v[208:211], v[192:195], v[144:147]
  ds_read_b64_tr_b16 v[220:221], v246 offset:23584
  v_mfma_f32_16x16x32_bf16 v[148:151], v[212:215], v[192:195], v[148:151]
  ds_read_b64_tr_b16 v[222:223], v246 offset:25376
  v_mfma_f32_16x16x32_bf16 v[152:155], v[208:211], v[196:199], v[152:155]
  ds_read_b128 v[232:235], v245 offset:0
  v_mfma_f32_16x16x32_bf16 v[156:159], v[212:215], v[196:199], v[156:159]
  ds_read_b128 v[236:239], v245 offset:2048
  s_waitcnt lgkmcnt(8)
  v_mfma_f32_16x16x32_bf16 v[160:163], v[32:35], v[200:203], v[160:163]
  ds_read_b64_tr_b16 v[224:225], v246 offset:23608
  v_mfma_f32_16x16x32_bf16 v[164:167], v[36:39], v[200:203], v[164:167]
  ds_read_b64_tr_b16 v[226:227], v246 offset:25400
  v_mfma_f32_16x16x32_bf16 v[168:171], v[32:35], v[204:207], v[168:171]
  ds_read_b64_tr_b16 v[228:229], v246 offset:23640
  v_mfma_f32_16x16x32_bf16 v[172:175], v[36:39], v[204:207], v[172:175]
  ds_read_b64_tr_b16 v[230:231], v246 offset:25432
  v_mfma_f32_16x16x32_bf16 v[176:179], v[208:211], v[200:203], v[176:179]
  v_mfma_f32_16x16x32_bf16 v[180:183], v[212:215], v[200:203], v[180:183]
  v_mfma_f32_16x16x32_bf16 v[184:187], v[208:211], v[204:207], v[184:187]
  v_mfma_f32_16x16x32_bf16 v[188:191], v[212:215], v[204:207], v[188:191]
  s_waitcnt lgkmcnt(6)
  v_mfma_f32_16x16x32_bf16 v[128:131], v[40:43], v[216:219], v[128:131]
  v_add_u32 v242, 30720, v242
  v_mfma_f32_16x16x32_bf16 v[132:135], v[44:47], v[216:219], v[132:135]
  v_add_u32 v243, 30720, v243
  v_mfma_f32_16x16x32_bf16 v[136:139], v[40:43], v[220:223], v[136:139]
  v_add_u32 v244, 30720, v244
  v_mfma_f32_16x16x32_bf16 v[140:143], v[44:47], v[220:223], v[140:143]
  v_add_u32 v245, 30720, v245
  v_add_u32 v246, 30720, v246
  s_waitcnt lgkmcnt(0)
  s_barrier
  v_mfma_f32_16x16x32_bf16 v[144:147], v[232:235], v[216:219], v[144:147]
  ds_read_b128 v[48:51], v242 offset:0
  v_mfma_f32_16x16x32_bf16 v[148:151], v[236:239], v[216:219], v[148:151]
  ds_read_b128 v[52:55], v242 offset:2048
  v_mfma_f32_16x16x32_bf16 v[152:155], v[232:235], v[220:223], v[152:155]
  ds_read_b64_tr_b16 v[192:193], v246 offset:16384
  v_mfma_f32_16x16x32_bf16 v[156:159], v[236:239], v[220:223], v[156:159]
  ds_read_b64_tr_b16 v[194:195], v246 offset:18176
  v_mfma_f32_16x16x32_bf16 v[160:163], v[40:43], v[224:227], v[160:163]
  ds_read_b64_tr_b16 v[196:197], v246 offset:16416
  v_mfma_f32_16x16x32_bf16 v[164:167], v[44:47], v[224:227], v[164:167]
  ds_read_b64_tr_b16 v[198:199], v246 offset:18208
  v_mfma_f32_16x16x32_bf16 v[168:171], v[40:43], v[228:231], v[168:171]
  ds_read_b128 v[208:211], v244 offset:0
  v_mfma_f32_16x16x32_bf16 v[172:175], v[44:47], v[228:231], v[172:175]
  ds_read_b128 v[212:215], v244 offset:2048
  v_mfma_f32_16x16x32_bf16 v[176:179], v[232:235], v[224:227], v[176:179]
  ds_read_b64_tr_b16 v[200:201], v246 offset:16440
  v_mfma_f32_16x16x32_bf16 v[180:183], v[236:239], v[224:227], v[180:183]
  ds_read_b64_tr_b16 v[202:203], v246 offset:18232
  v_mfma_f32_16x16x32_bf16 v[184:187], v[232:235], v[228:231], v[184:187]
  ds_read_b64_tr_b16 v[204:205], v246 offset:16472
  v_mfma_f32_16x16x32_bf16 v[188:191], v[236:239], v[228:231], v[188:191]
  ds_read_b64_tr_b16 v[206:207], v246 offset:18264
  s_waitcnt lgkmcnt(6)
  v_mfma_f32_16x16x32_bf16 v[128:131], v[48:51], v[192:195], v[128:131]
  ds_read_b128 v[56:59], v243 offset:0
  v_mfma_f32_16x16x32_bf16 v[132:135], v[52:55], v[192:195], v[132:135]
  ds_read_b128 v[60:63], v243 offset:2048
  v_mfma_f32_16x16x32_bf16 v[136:139], v[48:51], v[196:199], v[136:139]
  ds_read_b64_tr_b16 v[216:217], v246 offset:23552
  v_mfma_f32_16x16x32_bf16 v[140:143], v[52:55], v[196:199], v[140:143]
  ds_read_b64_tr_b16 v[218:219], v246 offset:25344
  s_waitcnt lgkmcnt(8)
  v_mfma_f32_16x16x32_bf16 v[144:147], v[208:211], v[192:195], v[144:147]
  ds_read_b64_tr_b16 v[220:221], v246 offset:23584
  v_mfma_f32_16x16x32_bf16 v[148:151], v[212:215], v[192:195], v[148:151]
  ds_read_b64_tr_b16 v[222:223], v246 offset:25376
  v_mfma_f32_16x16x32_bf16 v[152:155], v[208:211], v[196:199], v[152:155]
  ds_read_b128 v[232:235], v245 offset:0
  v_mfma_f32_16x16x32_bf16 v[156:159], v[212:215], v[196:199], v[156:159]
  ds_read_b128 v[236:239], v245 offset:2048
  s_waitcnt lgkmcnt(8)
  v_mfma_f32_16x16x32_bf16 v[160:163], v[48:51], v[200:203], v[160:163]
  ds_read_b64_tr_b16 v[224:225], v246 offset:23608
  v_mfma_f32_16x16x32_bf16 v[164:167], v[52:55], v[200:203], v[164:167]
  ds_read_b64_tr_b16 v[226:227], v246 offset:25400
  v_mfma_f32_16x16x32_bf16 v[168:171], v[48:51], v[204:207], v[168:171]
  ds_read_b64_tr_b16 v[228:229], v246 offset:23640
  v_mfma_f32_16x16x32_bf16 v[172:175], v[52:55], v[204:207], v[172:175]
  ds_read_b64_tr_b16 v[230:231], v246 offset:25432
  v_mfma_f32_16x16x32_bf16 v[176:179], v[208:211], v[200:203], v[176:179]
  v_mfma_f32_16x16x32_bf16 v[180:183], v[212:215], v[200:203], v[180:183]
  v_mfma_f32_16x16x32_bf16 v[184:187], v[208:211], v[204:207], v[184:187]
  v_mfma_f32_16x16x32_bf16 v[188:191], v[212:215], v[204:207], v[188:191]
  s_waitcnt lgkmcnt(6)
  v_mfma_f32_16x16x32_bf16 v[128:131], v[56:59], v[216:219], v[128:131]
  v_add_u32 v242, 4294905856, v242
  v_mfma_f32_16x16x32_bf16 v[132:135], v[60:63], v[216:219], v[132:135]
  v_add_u32 v243, 4294905856, v243
  v_mfma_f32_16x16x32_bf16 v[136:139], v[56:59], v[220:223], v[136:139]
  v_add_u32 v244, 4294905856, v244
  v_mfma_f32_16x16x32_bf16 v[140:143], v[60:63], v[220:223], v[140:143]
  v_add_u32 v245, 4294905856, v245
  v_add_u32 v246, 4294905856, v246
  s_waitcnt lgkmcnt(0)
  s_barrier
  v_mfma_f32_16x16x32_bf16 v[144:147], v[232:235], v[216:219], v[144:147]
  ds_read_b128 v[64:67], v242 offset:0
  v_mfma_f32_16x16x32_bf16 v[148:151], v[236:239], v[216:219], v[148:151]
  ds_read_b128 v[68:71], v242 offset:2048
  v_mfma_f32_16x16x32_bf16 v[152:155], v[232:235], v[220:223], v[152:155]
  ds_read_b64_tr_b16 v[192:193], v246 offset:16384
  v_mfma_f32_16x16x32_bf16 v[156:159], v[236:239], v[220:223], v[156:159]
  ds_read_b64_tr_b16 v[194:195], v246 offset:18176
  v_mfma_f32_16x16x32_bf16 v[160:163], v[56:59], v[224:227], v[160:163]
  ds_read_b64_tr_b16 v[196:197], v246 offset:16416
  v_mfma_f32_16x16x32_bf16 v[164:167], v[60:63], v[224:227], v[164:167]
  ds_read_b64_tr_b16 v[198:199], v246 offset:18208
  v_mfma_f32_16x16x32_bf16 v[168:171], v[56:59], v[228:231], v[168:171]
  ds_read_b128 v[208:211], v244 offset:0
  v_mfma_f32_16x16x32_bf16 v[172:175], v[60:63], v[228:231], v[172:175]
  ds_read_b128 v[212:215], v244 offset:2048
  v_mfma_f32_16x16x32_bf16 v[176:179], v[232:235], v[224:227], v[176:179]
  ds_read_b64_tr_b16 v[200:201], v246 offset:16440
  v_mfma_f32_16x16x32_bf16 v[180:183], v[236:239], v[224:227], v[180:183]
  ds_read_b64_tr_b16 v[202:203], v246 offset:18232
  v_mfma_f32_16x16x32_bf16 v[184:187], v[232:235], v[228:231], v[184:187]
  ds_read_b64_tr_b16 v[204:205], v246 offset:16472
  v_mfma_f32_16x16x32_bf16 v[188:191], v[236:239], v[228:231], v[188:191]
  ds_read_b64_tr_b16 v[206:207], v246 offset:18264
  s_waitcnt lgkmcnt(6)
  v_mfma_f32_16x16x32_bf16 v[128:131], v[64:67], v[192:195], v[128:131]
  ds_read_b128 v[72:75], v243 offset:0
  v_mfma_f32_16x16x32_bf16 v[132:135], v[68:71], v[192:195], v[132:135]
  ds_read_b128 v[76:79], v243 offset:2048
  v_mfma_f32_16x16x32_bf16 v[136:139], v[64:67], v[196:199], v[136:139]
  ds_read_b64_tr_b16 v[216:217], v246 offset:23552
  v_mfma_f32_16x16x32_bf16 v[140:143], v[68:71], v[196:199], v[140:143]
  ds_read_b64_tr_b16 v[218:219], v246 offset:25344
  s_waitcnt lgkmcnt(8)
  v_mfma_f32_16x16x32_bf16 v[144:147], v[208:211], v[192:195], v[144:147]
  ds_read_b64_tr_b16 v[220:221], v246 offset:23584
  v_mfma_f32_16x16x32_bf16 v[148:151], v[212:215], v[192:195], v[148:151]
  ds_read_b64_tr_b16 v[222:223], v246 offset:25376
  v_mfma_f32_16x16x32_bf16 v[152:155], v[208:211], v[196:199], v[152:155]
  ds_read_b128 v[232:235], v245 offset:0
  v_mfma_f32_16x16x32_bf16 v[156:159], v[212:215], v[196:199], v[156:159]
  ds_read_b128 v[236:239], v245 offset:2048
  s_waitcnt lgkmcnt(8)
  v_mfma_f32_16x16x32_bf16 v[160:163], v[64:67], v[200:203], v[160:163]
  ds_read_b64_tr_b16 v[224:225], v246 offset:23608
  v_mfma_f32_16x16x32_bf16 v[164:167], v[68:71], v[200:203], v[164:167]
  ds_read_b64_tr_b16 v[226:227], v246 offset:25400
  v_mfma_f32_16x16x32_bf16 v[168:171], v[64:67], v[204:207], v[168:171]
  ds_read_b64_tr_b16 v[228:229], v246 offset:23640
  v_mfma_f32_16x16x32_bf16 v[172:175], v[68:71], v[204:207], v[172:175]
  ds_read_b64_tr_b16 v[230:231], v246 offset:25432
  v_mfma_f32_16x16x32_bf16 v[176:179], v[208:211], v[200:203], v[176:179]
  v_mfma_f32_16x16x32_bf16 v[180:183], v[212:215], v[200:203], v[180:183]
  v_mfma_f32_16x16x32_bf16 v[184:187], v[208:211], v[204:207], v[184:187]
  v_mfma_f32_16x16x32_bf16 v[188:191], v[212:215], v[204:207], v[188:191]
  s_waitcnt lgkmcnt(6)
  v_mfma_f32_16x16x32_bf16 v[128:131], v[72:75], v[216:219], v[128:131]
  v_add_u32 v242, 30720, v242
  v_mfma_f32_16x16x32_bf16 v[132:135], v[76:79], v[216:219], v[132:135]
  v_add_u32 v243, 30720, v243
  v_mfma_f32_16x16x32_bf16 v[136:139], v[72:75], v[220:223], v[136:139]
  v_add_u32 v244, 30720, v244
  v_mfma_f32_16x16x32_bf16 v[140:143], v[76:79], v[220:223], v[140:143]
  v_add_u32 v245, 30720, v245
  v_add_u32 v246, 30720, v246
  s_waitcnt lgkmcnt(0)
  s_barrier
  buffer_load_dwordx2 v[252:253], v255, s[44:47], 0 offen sc1
  v_mfma_f32_16x16x32_bf16 v[144:147], v[232:235], v[216:219], v[144:147]
  ds_read_b128 v[80:83], v242 offset:0
  v_mfma_f32_16x16x32_bf16 v[148:151], v[236:239], v[216:219], v[148:151]
  ds_read_b128 v[84:87], v242 offset:2048
  v_mfma_f32_16x16x32_bf16 v[152:155], v[232:235], v[220:223], v[152:155]
  ds_read_b64_tr_b16 v[192:193], v246 offset:16384
  v_mfma_f32_16x16x32_bf16 v[156:159], v[236:239], v[220:223], v[156:159]
  ds_read_b64_tr_b16 v[194:195], v246 offset:18176
  v_mfma_f32_16x16x32_bf16 v[160:163], v[72:75], v[224:227], v[160:163]
  ds_read_b64_tr_b16 v[196:197], v246 offset:16416
  v_mfma_f32_16x16x32_bf16 v[164:167], v[76:79], v[224:227], v[164:167]
  ds_read_b64_tr_b16 v[198:199], v246 offset:18208
  v_mfma_f32_16x16x32_bf16 v[168:171], v[72:75], v[228:231], v[168:171]
  ds_read_b128 v[208:211], v244 offset:0
  v_mfma_f32_16x16x32_bf16 v[172:175], v[76:79], v[228:231], v[172:175]
  ds_read_b128 v[212:215], v244 offset:2048
  v_mfma_f32_16x16x32_bf16 v[176:179], v[232:235], v[224:227], v[176:179]
  ds_read_b64_tr_b16 v[200:201], v246 offset:16440
  v_mfma_f32_16x16x32_bf16 v[180:183], v[236:239], v[224:227], v[180:183]
  ds_read_b64_tr_b16 v[202:203], v246 offset:18232
  v_mfma_f32_16x16x32_bf16 v[184:187], v[232:235], v[228:231], v[184:187]
  ds_read_b64_tr_b16 v[204:205], v246 offset:16472
  v_mfma_f32_16x16x32_bf16 v[188:191], v[236:239], v[228:231], v[188:191]
  ds_read_b64_tr_b16 v[206:207], v246 offset:18264
  s_waitcnt lgkmcnt(6)
  v_mfma_f32_16x16x32_bf16 v[128:131], v[80:83], v[192:195], v[128:131]
  ds_read_b128 v[88:91], v243 offset:0
  v_mfma_f32_16x16x32_bf16 v[132:135], v[84:87], v[192:195], v[132:135]
  ds_read_b128 v[92:95], v243 offset:2048
  v_mfma_f32_16x16x32_bf16 v[136:139], v[80:83], v[196:199], v[136:139]
  ds_read_b64_tr_b16 v[216:217], v246 offset:23552
  v_mfma_f32_16x16x32_bf16 v[140:143], v[84:87], v[196:199], v[140:143]
  ds_read_b64_tr_b16 v[218:219], v246 offset:25344
  s_waitcnt lgkmcnt(8)
  v_mfma_f32_16x16x32_bf16 v[144:147], v[208:211], v[192:195], v[144:147]
  ds_read_b64_tr_b16 v[220:221], v246 offset:23584
  v_mfma_f32_16x16x32_bf16 v[148:151], v[212:215], v[192:195], v[148:151]
  ds_read_b64_tr_b16 v[222:223], v246 offset:25376
  v_mfma_f32_16x16x32_bf16 v[152:155], v[208:211], v[196:199], v[152:155]
  ds_read_b128 v[232:235], v245 offset:0
  v_mfma_f32_16x16x32_bf16 v[156:159], v[212:215], v[196:199], v[156:159]
  ds_read_b128 v[236:239], v245 offset:2048
  s_waitcnt lgkmcnt(8)
  v_mfma_f32_16x16x32_bf16 v[160:163], v[80:83], v[200:203], v[160:163]
  ds_read_b64_tr_b16 v[224:225], v246 offset:23608
  v_mfma_f32_16x16x32_bf16 v[164:167], v[84:87], v[200:203], v[164:167]
  ds_read_b64_tr_b16 v[226:227], v246 offset:25400
  v_mfma_f32_16x16x32_bf16 v[168:171], v[80:83], v[204:207], v[168:171]
  ds_read_b64_tr_b16 v[228:229], v246 offset:23640
  v_mfma_f32_16x16x32_bf16 v[172:175], v[84:87], v[204:207], v[172:175]
  ds_read_b64_tr_b16 v[230:231], v246 offset:25432
  v_mfma_f32_16x16x32_bf16 v[176:179], v[208:211], v[200:203], v[176:179]
  v_mfma_f32_16x16x32_bf16 v[180:183], v[212:215], v[200:203], v[180:183]
  v_mfma_f32_16x16x32_bf16 v[184:187], v[208:211], v[204:207], v[184:187]
  v_mfma_f32_16x16x32_bf16 v[188:191], v[212:215], v[204:207], v[188:191]
  s_waitcnt lgkmcnt(6)
  v_mfma_f32_16x16x32_bf16 v[128:131], v[88:91], v[216:219], v[128:131]
  v_add_u32 v242, 30720, v242
  v_mfma_f32_16x16x32_bf16 v[132:135], v[92:95], v[216:219], v[132:135]
  v_add_u32 v243, 30720, v243
  v_mfma_f32_16x16x32_bf16 v[136:139], v[88:91], v[220:223], v[136:139]
  v_add_u32 v244, 30720, v244
  v_mfma_f32_16x16x32_bf16 v[140:143], v[92:95], v[220:223], v[140:143]
  v_add_u32 v245, 30720, v245
  v_add_u32 v246, 30720, v246
  s_waitcnt lgkmcnt(0)
  s_barrier
  v_mfma_f32_16x16x32_bf16 v[144:147], v[232:235], v[216:219], v[144:147]
  ds_read_b128 v[96:99], v242 offset:0
  v_mfma_f32_16x16x32_bf16 v[148:151], v[236:239], v[216:219], v[148:151]
  ds_read_b128 v[100:103], v242 offset:2048
  v_mfma_f32_16x16x32_bf16 v[152:155], v[232:235], v[220:223], v[152:155]
  ds_read_b64_tr_b16 v[192:193], v246 offset:16384
  v_mfma_f32_16x16x32_bf16 v[156:159], v[236:239], v[220:223], v[156:159]
  ds_read_b64_tr_b16 v[194:195], v246 offset:18176
  v_mfma_f32_16x16x32_bf16 v[160:163], v[88:91], v[224:227], v[160:163]
  ds_read_b64_tr_b16 v[196:197], v246 offset:16416
  v_mfma_f32_16x16x32_bf16 v[164:167], v[92:95], v[224:227], v[164:167]
  ds_read_b64_tr_b16 v[198:199], v246 offset:18208
  v_mfma_f32_16x16x32_bf16 v[168:171], v[88:91], v[228:231], v[168:171]
  ds_read_b128 v[208:211], v244 offset:0
  v_mfma_f32_16x16x32_bf16 v[172:175], v[92:95], v[228:231], v[172:175]
  ds_read_b128 v[212:215], v244 offset:2048
  v_mfma_f32_16x16x32_bf16 v[176:179], v[232:235], v[224:227], v[176:179]
  ds_read_b64_tr_b16 v[200:201], v246 offset:16440
  v_mfma_f32_16x16x32_bf16 v[180:183], v[236:239], v[224:227], v[180:183]
  ds_read_b64_tr_b16 v[202:203], v246 offset:18232
  v_mfma_f32_16x16x32_bf16 v[184:187], v[232:235], v[228:231], v[184:187]
  ds_read_b64_tr_b16 v[204:205], v246 offset:16472
  v_mfma_f32_16x16x32_bf16 v[188:191], v[236:239], v[228:231], v[188:191]
  ds_read_b64_tr_b16 v[206:207], v246 offset:18264
  s_waitcnt lgkmcnt(6)
  v_mfma_f32_16x16x32_bf16 v[128:131], v[96:99], v[192:195], v[128:131]
  ds_read_b128 v[104:107], v243 offset:0
  v_mfma_f32_16x16x32_bf16 v[132:135], v[100:103], v[192:195], v[132:135]
  ds_read_b128 v[108:111], v243 offset:2048
  v_mfma_f32_16x16x32_bf16 v[136:139], v[96:99], v[196:199], v[136:139]
  ds_read_b64_tr_b16 v[216:217], v246 offset:23552
  v_mfma_f32_16x16x32_bf16 v[140:143], v[100:103], v[196:199], v[140:143]
  ds_read_b64_tr_b16 v[218:219], v246 offset:25344
  s_waitcnt lgkmcnt(8)
  v_mfma_f32_16x16x32_bf16 v[144:147], v[208:211], v[192:195], v[144:147]
  ds_read_b64_tr_b16 v[220:221], v246 offset:23584
  v_mfma_f32_16x16x32_bf16 v[148:151], v[212:215], v[192:195], v[148:151]
  ds_read_b64_tr_b16 v[222:223], v246 offset:25376
  v_mfma_f32_16x16x32_bf16 v[152:155], v[208:211], v[196:199], v[152:155]
  ds_read_b128 v[232:235], v245 offset:0
  v_mfma_f32_16x16x32_bf16 v[156:159], v[212:215], v[196:199], v[156:159]
  ds_read_b128 v[236:239], v245 offset:2048
  s_waitcnt lgkmcnt(8)
  v_mfma_f32_16x16x32_bf16 v[160:163], v[96:99], v[200:203], v[160:163]
  ds_read_b64_tr_b16 v[224:225], v246 offset:23608
  v_mfma_f32_16x16x32_bf16 v[164:167], v[100:103], v[200:203], v[164:167]
  ds_read_b64_tr_b16 v[226:227], v246 offset:25400
  v_mfma_f32_16x16x32_bf16 v[168:171], v[96:99], v[204:207], v[168:171]
  ds_read_b64_tr_b16 v[228:229], v246 offset:23640
  v_mfma_f32_16x16x32_bf16 v[172:175], v[100:103], v[204:207], v[172:175]
  ds_read_b64_tr_b16 v[230:231], v246 offset:25432
  v_mfma_f32_16x16x32_bf16 v[176:179], v[208:211], v[200:203], v[176:179]
  v_mfma_f32_16x16x32_bf16 v[180:183], v[212:215], v[200:203], v[180:183]
  v_mfma_f32_16x16x32_bf16 v[184:187], v[208:211], v[204:207], v[184:187]
  v_mfma_f32_16x16x32_bf16 v[188:191], v[212:215], v[204:207], v[188:191]
  s_waitcnt lgkmcnt(6)
  v_mfma_f32_16x16x32_bf16 v[128:131], v[104:107], v[216:219], v[128:131]
  v_add_u32 v242, 4294905856, v242
  v_mfma_f32_16x16x32_bf16 v[132:135], v[108:111], v[216:219], v[132:135]
  v_add_u32 v243, 4294905856, v243
  v_mfma_f32_16x16x32_bf16 v[136:139], v[104:107], v[220:223], v[136:139]
  v_add_u32 v244, 4294905856, v244
  v_mfma_f32_16x16x32_bf16 v[140:143], v[108:111], v[220:223], v[140:143]
  v_add_u32 v245, 4294905856, v245
  v_add_u32 v246, 4294905856, v246
  s_waitcnt lgkmcnt(4)
  v_mfma_f32_16x16x32_bf16 v[144:147], v[232:235], v[216:219], v[144:147]
  v_mfma_f32_16x16x32_bf16 v[148:151], v[236:239], v[216:219], v[148:151]
  v_mfma_f32_16x16x32_bf16 v[152:155], v[232:235], v[220:223], v[152:155]
  v_mfma_f32_16x16x32_bf16 v[156:159], v[236:239], v[220:223], v[156:159]
  s_waitcnt lgkmcnt(0)
  s_mov_b32 s3, 200000
  s_branch L_non_13_chk
L_non_13:
  buffer_load_dwordx2 v[252:253], v255, s[44:47], 0 offen sc1
L_non_13_chk:
  s_waitcnt vmcnt(0)
  v_readfirstlane_b32 s54, v252
  v_readfirstlane_b32 s55, v253
  s_sub_u32 s3, s3, 1
  s_cbranch_scc1 L_non_done_14
  s_cmp_eq_u32 s54, 0
  s_cbranch_scc1 L_non_13
L_non_done_14:
  s_barrier
  v_mfma_f32_16x16x32_bf16 v[160:163], v[104:107], v[224:227], v[160:163]
  ds_read_b128 v[112:115], v242 offset:0
  ds_read_b128 v[116:119], v242 offset:2048
  v_mfma_f32_16x16x32_bf16 v[164:167], v[108:111], v[224:227], v[164:167]
  ds_read_b64_tr_b16 v[192:193], v246 offset:16384
  ds_read_b64_tr_b16 v[194:195], v246 offset:18176
  v_mfma_f32_16x16x32_bf16 v[168:171], v[104:107], v[228:231], v[168:171]
  ds_read_b64_tr_b16 v[196:197], v246 offset:16416
  ds_read_b64_tr_b16 v[198:199], v246 offset:18208
  v_mfma_f32_16x16x32_bf16 v[172:175], v[108:111], v[228:231], v[172:175]
  ds_read_b128 v[120:123], v243 offset:0
  ds_read_b128 v[124:127], v243 offset:2048
  v_mfma_f32_16x16x32_bf16 v[176:179], v[232:235], v[224:227], v[176:179]
  ds_read_b64_tr_b16 v[216:217], v246 offset:23552
  ds_read_b64_tr_b16 v[218:219], v246 offset:25344
  v_mfma_f32_16x16x32_bf16 v[180:183], v[236:239], v[224:227], v[180:183]
  ds_read_b64_tr_b16 v[220:221], v246 offset:23584
  ds_read_b64_tr_b16 v[222:223], v246 offset:25376
  v_mfma_f32_16x16x32_bf16 v[184:187], v[232:235], v[228:231], v[184:187]
  ds_read_b128 v[208:211], v244 offset:0
  ds_read_b128 v[212:215], v244 offset:2048
  v_mfma_f32_16x16x32_bf16 v[188:191], v[236:239], v[228:231], v[188:191]
  s_cmp_lt_u32 s53, 8
  s_waitcnt lgkmcnt(8)
  v_mfma_f32_16x16x32_bf16 v[128:131], v[112:115], v[192:195], v[128:131]
  ds_read_b128 v[232:235], v245 offset:0
  ds_read_b128 v[236:239], v245 offset:2048
  v_mfma_f32_16x16x32_bf16 v[132:135], v[116:119], v[192:195], v[132:135]
  ds_read_b64_tr_b16 v[200:201], v246 offset:16440
  ds_read_b64_tr_b16 v[202:203], v246 offset:18232
  v_mfma_f32_16x16x32_bf16 v[136:139], v[112:115], v[196:199], v[136:139]
  ds_read_b64_tr_b16 v[204:205], v246 offset:16472
  ds_read_b64_tr_b16 v[206:207], v246 offset:18264
  v_mfma_f32_16x16x32_bf16 v[140:143], v[116:119], v[196:199], v[140:143]
  ds_read_b64_tr_b16 v[224:225], v246 offset:23608
  ds_read_b64_tr_b16 v[226:227], v246 offset:25400
  s_waitcnt lgkmcnt(10)
  v_mfma_f32_16x16x32_bf16 v[128:131], v[120:123], v[216:219], v[128:131]
  ds_read_b64_tr_b16 v[228:229], v246 offset:23640
  ds_read_b64_tr_b16 v[230:231], v246 offset:25432
  v_mfma_f32_16x16x32_bf16 v[132:135], v[124:127], v[216:219], v[132:135]
  v_mfma_f32_16x16x32_bf16 v[136:139], v[120:123], v[220:223], v[136:139]
  v_mfma_f32_16x16x32_bf16 v[140:143], v[124:127], v[220:223], v[140:143]
  s_waitcnt lgkmcnt(10)
  v_mfma_f32_16x16x32_bf16 v[144:147], v[208:211], v[192:195], v[144:147]
  v_mfma_f32_16x16x32_bf16 v[148:151], v[212:215], v[192:195], v[148:151]
  v_mfma_f32_16x16x32_bf16 v[152:155], v[208:211], v[196:199], v[152:155]
  v_mfma_f32_16x16x32_bf16 v[156:159], v[212:215], v[196:199], v[156:159]
  s_waitcnt lgkmcnt(8)
  v_mfma_f32_16x16x32_bf16 v[144:147], v[232:235], v[216:219], v[144:147]
  v_mfma_f32_16x16x32_bf16 v[148:151], v[236:239], v[216:219], v[148:151]
  v_cvt_pk_bf16_f32 v248, v128, v129
  v_cvt_pk_bf16_f32 v249, v130, v131
  v_mfma_f32_16x16x32_bf16 v[152:155], v[232:235], v[220:223], v[152:155]
  v_cvt_pk_bf16_f32 v250, v132, v133
  v_cvt_pk_bf16_f32 v251, v134, v135
  v_mfma_f32_16x16x32_bf16 v[156:159], v[236:239], v[220:223], v[156:159]
  v_cvt_pk_bf16_f32 v242, v136, v137
  v_cvt_pk_bf16_f32 v243, v138, v139
  s_waitcnt lgkmcnt(4)
  v_mfma_f32_16x16x32_bf16 v[160:163], v[112:115], v[200:203], v[160:163]
  v_cvt_pk_bf16_f32 v244, v140, v141
  v_cvt_pk_bf16_f32 v245, v142, v143
  v_mfma_f32_16x16x32_bf16 v[164:167], v[116:119], v[200:203], v[164:167]
  v_and_or_b32 v242, v242, v247, v241
  v_and_or_b32 v243, v243, v247, v241
  v_mfma_f32_16x16x32_bf16 v[168:171], v[112:115], v[204:207], v[168:171]
  v_and_or_b32 v244, v244, v247, v241
  v_and_or_b32 v245, v245, v247, v241
  v_mfma_f32_16x16x32_bf16 v[172:175], v[116:119], v[204:207], v[172:175]
  s_cbranch_scc1 L_nost_15
  buffer_store_dwordx4 v[248:251], v240, s[24:27], s10 offen sc1
  buffer_store_dwordx4 v[242:245], v240, s[24:27], s10 offen offset:256 sc1
L_nost_15:
  s_waitcnt lgkmcnt(0)
  v_mfma_f32_16x16x32_bf16 v[160:163], v[120:123], v[224:227], v[160:163]
  v_mfma_f32_16x16x32_bf16 v[164:167], v[124:127], v[224:227], v[164:167]
  v_cvt_pk_bf16_f32 v192, v144, v145
  v_cvt_pk_bf16_f32 v193, v146, v147
  v_mfma_f32_16x16x32_bf16 v[168:171], v[120:123], v[228:231], v[168:171]
  v_cvt_pk_bf16_f32 v194, v148, v149
  v_cvt_pk_bf16_f32 v195, v150, v151
  v_mfma_f32_16x16x32_bf16 v[172:175], v[124:127], v[228:231], v[172:175]
  v_cvt_pk_bf16_f32 v196, v152, v153
  v_cvt_pk_bf16_f32 v197, v154, v155
  v_mfma_f32_16x16x32_bf16 v[176:179], v[208:211], v[200:203], v[176:179]
  v_cvt_pk_bf16_f32 v198, v156, v157
  v_cvt_pk_bf16_f32 v199, v158, v159
  v_mfma_f32_16x16x32_bf16 v[180:183], v[212:215], v[200:203], v[180:183]
  v_and_or_b32 v196, v196, v247, v241
  v_and_or_b32 v197, v197, v247, v241
  v_mfma_f32_16x16x32_bf16 v[184:187], v[208:211], v[204:207], v[184:187]
  v_and_or_b32 v198, v198, v247, v241
  v_and_or_b32 v199, v199, v247, v241
  v_mfma_f32_16x16x32_bf16 v[188:191], v[212:215], v[204:207], v[188:191]
  s_cbranch_scc1 L_nost_16
  buffer_store_dwordx4 v[192:195], v240, s[24:27], s12 offen sc1
  buffer_store_dwordx4 v[196:199], v240, s[24:27], s12 offen offset:256 sc1
L_nost_16:
  v_mfma_f32_16x16x32_bf16 v[176:179], v[232:235], v[224:227], v[176:179]
  v_mfma_f32_16x16x32_bf16 v[180:183], v[236:239], v[224:227], v[180:183]
  v_cvt_pk_bf16_f32 v216, v160, v161
  v_cvt_pk_bf16_f32 v217, v162, v163
  v_mfma_f32_16x16x32_bf16 v[184:187], v[232:235], v[228:231], v[184:187]
  v_cvt_pk_bf16_f32 v218, v164, v165
  v_cvt_pk_bf16_f32 v219, v166, v167
  v_mfma_f32_16x16x32_bf16 v[188:191], v[236:239], v[228:231], v[188:191]
  v_cvt_pk_bf16_f32 v220, v168, v169
  v_cvt_pk_bf16_f32 v221, v170, v171
  v_cvt_pk_bf16_f32 v222, v172, v173
  v_cvt_pk_bf16_f32 v223, v174, v175
  v_and_or_b32 v220, v220, v247, v241
  v_and_or_b32 v221, v221, v247, v241
  v_and_or_b32 v222, v222, v247, v241
  v_and_or_b32 v223, v223, v247, v241
  s_cbranch_scc1 L_nost_17
  buffer_store_dwordx4 v[216:219], v240, s[24:27], s13 offen sc1
  buffer_store_dwordx4 v[220:223], v240, s[24:27], s13 offen offset:256 sc1
L_nost_17:
  s_nop 0
  v_cvt_pk_bf16_f32 v200, v176, v177
  v_cvt_pk_bf16_f32 v201, v178, v179
  v_cvt_pk_bf16_f32 v202, v180, v181
  v_cvt_pk_bf16_f32 v203, v182, v183
  v_cvt_pk_bf16_f32 v204, v184, v185
  v_cvt_pk_bf16_f32 v205, v186, v187
  v_cvt_pk_bf16_f32 v206, v188, v189
  v_cvt_pk_bf16_f32 v207, v190, v191
  v_and_or_b32 v204, v204, v247, v241
  v_and_or_b32 v205, v205, v247, v241
  v_and_or_b32 v206, v206, v247, v241
  v_and_or_b32 v207, v207, v247, v241
  s_cbranch_scc1 L_nost_18
  buffer_store_dwordx4 v[200:203], v240, s[24:27], s14 offen sc1
  buffer_store_dwordx4 v[204:207], v240, s[24:27], s14 offen offset:256 sc1
L_nost_18:
L_1a_join:
  s_barrier
  ds_read_b64_tr_b16 v[160:161], v14 offset:0
  ds_read_b64_tr_b16 v[162:163], v14 offset:256
  ds_read_b64_tr_b16 v[164:165], v9 offset:0
  ds_read_b64_tr_b16 v[166:167], v9 offset:256
  ds_read_b64_tr_b16 v[168:169], v14 offset:2048
  ds_read_b64_tr_b16 v[170:171], v14 offset:2304
  ds_read_b64_tr_b16 v[172:173], v9 offset:2048
  ds_read_b64_tr_b16 v[174:175], v9 offset:2304
  ds_read_b64_tr_b16 v[176:177], v14 offset:4096
  ds_read_b64_tr_b16 v[178:179], v14 offset:4352
  ds_read_b64_tr_b16 v[180:181], v9 offset:4096
  ds_read_b64_tr_b16 v[182:183], v9 offset:4352
  s_waitcnt lgkmcnt(8)
  v_mfma_f32_16x16x32_bf16 v[144:147], v[160:163], v[16:19], 0
  ds_read_b64_tr_b16 v[184:185], v14 offset:6144
  v_mfma_f32_16x16x32_bf16 v[148:151], v[164:167], v[16:19], 0
  ds_read_b64_tr_b16 v[186:187], v14 offset:6400
  v_mfma_f32_16x16x32_bf16 v[152:155], v[160:163], v[20:23], 0
  ds_read_b64_tr_b16 v[188:189], v9 offset:6144
  v_mfma_f32_16x16x32_bf16 v[156:159], v[164:167], v[20:23], 0
  ds_read_b64_tr_b16 v[190:191], v9 offset:6400
  s_waitcnt lgkmcnt(8)
  v_mfma_f32_16x16x32_bf16 v[144:147], v[168:171], v[24:27], v[144:147]
  ds_read_b64_tr_b16 v[160:161], v14 offset:8192
  v_mfma_f32_16x16x32_bf16 v[148:151], v[172:175], v[24:27], v[148:151]
  ds_read_b64_tr_b16 v[162:163], v14 offset:8448
  v_mfma_f32_16x16x32_bf16 v[152:155], v[168:171], v[28:31], v[152:155]
  ds_read_b64_tr_b16 v[164:165], v9 offset:8192
  v_mfma_f32_16x16x32_bf16 v[156:159], v[172:175], v[28:31], v[156:159]
  ds_read_b64_tr_b16 v[166:167], v9 offset:8448
  s_waitcnt lgkmcnt(8)
  v_mfma_f32_16x16x32_bf16 v[144:147], v[176:179], v[32:35], v[144:147]
  ds_read_b64_tr_b16 v[168:169], v14 offset:10240
  v_mfma_f32_16x16x32_bf16 v[148:151], v[180:183], v[32:35], v[148:151]
  ds_read_b64_tr_b16 v[170:171], v14 offset:10496
  v_mfma_f32_16x16x32_bf16 v[152:155], v[176:179], v[36:39], v[152:155]
  ds_read_b64_tr_b16 v[172:173], v9 offset:10240
  v_mfma_f32_16x16x32_bf16 v[156:159], v[180:183], v[36:39], v[156:159]
  ds_read_b64_tr_b16 v[174:175], v9 offset:10496
  s_waitcnt lgkmcnt(8)
  v_mfma_f32_16x16x32_bf16 v[144:147], v[184:187], v[40:43], v[144:147]
  ds_read_b64_tr_b16 v[176:177], v14 offset:12288
  v_mfma_f32_16x16x32_bf16 v[148:151], v[188:191], v[40:43], v[148:151]
  ds_read_b64_tr_b16 v[178:179], v14 offset:12544
  v_mfma_f32_16x16x32_bf16 v[152:155], v[184:187], v[44:47], v[152:155]
  ds_read_b64_tr_b16 v[180:181], v9 offset:12288
  v_mfma_f32_16x16x32_bf16 v[156:159], v[188:191], v[44:47], v[156:159]
  ds_read_b64_tr_b16 v[182:183], v9 offset:12544
  s_waitcnt lgkmcnt(8)
  v_mfma_f32_16x16x32_bf16 v[144:147], v[160:163], v[48:51], v[144:147]
  ds_read_b64_tr_b16 v[184:185], v14 offset:14336
  v_mfma_f32_16x16x32_bf16 v[148:151], v[164:167], v[48:51], v[148:151]
  ds_read_b64_tr_b16 v[186:187], v14 offset:14592
  v_mfma_f32_16x16x32_bf16 v[152:155], v[160:163], v[52:55], v[152:155]
  ds_read_b64_tr_b16 v[188:189], v9 offset:14336
  v_mfma_f32_16x16x32_bf16 v[156:159], v[164:167], v[52:55], v[156:159]
  ds_read_b64_tr_b16 v[190:191], v9 offset:14592
  s_waitcnt lgkmcnt(8)
  v_mfma_f32_16x16x32_bf16 v[144:147], v[168:171], v[56:59], v[144:147]
  ds_read_b64_tr_b16 v[160:161], v14 offset:16384
  v_mfma_f32_16x16x32_bf16 v[148:151], v[172:175], v[56:59], v[148:151]
  ds_read_b64_tr_b16 v[162:163], v14 offset:16640
  v_mfma_f32_16x16x32_bf16 v[152:155], v[168:171], v[60:63], v[152:155]
  ds_read_b64_tr_b16 v[164:165], v9 offset:16384
  v_mfma_f32_16x16x32_bf16 v[156:159], v[172:175], v[60:63], v[156:159]
  ds_read_b64_tr_b16 v[166:167], v9 offset:16640
  s_waitcnt lgkmcnt(8)
  v_mfma_f32_16x16x32_bf16 v[144:147], v[176:179], v[64:67], v[144:147]
  ds_read_b64_tr_b16 v[168:169], v14 offset:18432
  v_mfma_f32_16x16x32_bf16 v[148:151], v[180:183], v[64:67], v[148:151]
  ds_read_b64_tr_b16 v[170:171], v14 offset:18688
  v_mfma_f32_16x16x32_bf16 v[152:155], v[176:179], v[68:71], v[152:155]
  ds_read_b64_tr_b16 v[172:173], v9 offset:18432
  v_mfma_f32_16x16x32_bf16 v[156:159], v[180:183], v[68:71], v[156:159]
  ds_read_b64_tr_b16 v[174:175], v9 offset:18688
  s_waitcnt lgkmcnt(8)
  v_mfma_f32_16x16x32_bf16 v[144:147], v[184:187], v[72:75], v[144:147]
  ds_read_b64_tr_b16 v[176:177], v14 offset:20480
  v_mfma_f32_16x16x32_bf16 v[148:151], v[188:191], v[72:75], v[148:151]
  ds_read_b64_tr_b16 v[178:179], v14 offset:20736
  v_mfma_f32_16x16x32_bf16 v[152:155], v[184:187], v[76:79], v[152:155]
  ds_read_b64_tr_b16 v[180:181], v9 offset:20480
  v_mfma_f32_16x16x32_bf16 v[156:159], v[188:191], v[76:79], v[156:159]
  ds_read_b64_tr_b16 v[182:183], v9 offset:20736
  s_waitcnt lgkmcnt(8)
  v_mfma_f32_16x16x32_bf16 v[144:147], v[160:163], v[80:83], v[144:147]
  ds_read_b64_tr_b16 v[184:185], v14 offset:22528
  v_mfma_f32_16x16x32_bf16 v[148:151], v[164:167], v[80:83], v[148:151]
  ds_read_b64_tr_b16 v[186:187], v14 offset:22784
  v_mfma_f32_16x16x32_bf16 v[152:155], v[160:163], v[84:87], v[152:155]
  ds_read_b64_tr_b16 v[188:189], v9 offset:22528
  v_mfma_f32_16x16x32_bf16 v[156:159], v[164:167], v[84:87], v[156:159]
  ds_read_b64_tr_b16 v[190:191], v9 offset:22784
  s_waitcnt lgkmcnt(8)
  v_mfma_f32_16x16x32_bf16 v[144:147], v[168:171], v[88:91], v[144:147]
  ds_read_b64_tr_b16 v[160:161], v14 offset:24576
  v_mfma_f32_16x16x32_bf16 v[148:151], v[172:175], v[88:91], v[148:151]
  ds_read_b64_tr_b16 v[162:163], v14 offset:24832
  v_mfma_f32_16x16x32_bf16 v[152:155], v[168:171], v[92:95], v[152:155]
  ds_read_b64_tr_b16 v[164:165], v9 offset:24576
  v_mfma_f32_16x16x32_bf16 v[156:159], v[172:175], v[92:95], v[156:159]
  ds_read_b64_tr_b16 v[166:167], v9 offset:24832
  s_waitcnt lgkmcnt(8)
  v_mfma_f32_16x16x32_bf16 v[144:147], v[176:179], v[96:99], v[144:147]
  ds_read_b64_tr_b16 v[168:169], v14 offset:26624
  v_mfma_f32_16x16x32_bf16 v[148:151], v[180:183], v[96:99], v[148:151]
  ds_read_b64_tr_b16 v[170:171], v14 offset:26880
  v_mfma_f32_16x16x32_bf16 v[152:155], v[176:179], v[100:103], v[152:155]
  ds_read_b64_tr_b16 v[172:173], v9 offset:26624
  v_mfma_f32_16x16x32_bf16 v[156:159], v[180:183], v[100:103], v[156:159]
  ds_read_b64_tr_b16 v[174:175], v9 offset:26880
  s_waitcnt lgkmcnt(8)
  v_mfma_f32_16x16x32_bf16 v[144:147], v[184:187], v[104:107], v[144:147]
  v_mfma_f32_16x16x32_bf16 v[148:151], v[188:191], v[104:107], v[148:151]
  v_mfma_f32_16x16x32_bf16 v[152:155], v[184:187], v[108:111], v[152:155]
  v_mfma_f32_16x16x32_bf16 v[156:159], v[188:191], v[108:111], v[156:159]
  s_waitcnt lgkmcnt(4)
  v_mfma_f32_16x16x32_bf16 v[144:147], v[160:163], v[112:115], v[144:147]
  v_mfma_f32_16x16x32_bf16 v[148:151], v[164:167], v[112:115], v[148:151]
  v_mfma_f32_16x16x32_bf16 v[152:155], v[160:163], v[116:119], v[152:155]
  v_mfma_f32_16x16x32_bf16 v[156:159], v[164:167], v[116:119], v[156:159]
  s_waitcnt lgkmcnt(0)
  v_mfma_f32_16x16x32_bf16 v[144:147], v[168:171], v[120:123], v[144:147]
  v_mfma_f32_16x16x32_bf16 v[148:151], v[172:175], v[120:123], v[148:151]
  v_mfma_f32_16x16x32_bf16 v[152:155], v[168:171], v[124:127], v[152:155]
  v_mfma_f32_16x16x32_bf16 v[156:159], v[172:175], v[124:127], v[156:159]
  s_cmp_lt_u32 s53, 8
  s_cbranch_scc1 L_noflag
  s_waitcnt vmcnt(0)
  s_mov_b64 exec, 1
  ds_add_rtn_u32 v11, v255, v5 offset:0
  s_waitcnt lgkmcnt(0)
  v_cmp_eq_u32 vcc, 3, v11
  s_cbranch_vccz L_nosig_19
  buffer_store_dwordx2 v[252:253], v255, s[24:27], s19 offen sc1
L_nosig_19:
  s_mov_b64 exec, -1
L_noflag:
  s_barrier
  s_bfe_u32 s64, s53, 0x10002
  s_add_u32 s65, s64, 2
  s_lshl_b32 s64, s64, 1
  s_lshr_b32 s64, 16, s64
  v_bfe_u32 v228, v0, 2, 2
  v_and_b32 v229, 3, v0
  v_lshl_add_u32 v228, v228, s65, v229
  v_add_u32 v229, s64, v228
  s_lshl_b32 s64, s52, 8
  s_add_u32 s64, s64, 95232
  v_lshl_add_u32 v246, v228, 3, s64
  v_lshl_add_u32 v247, v229, 3, s64
  s_lshl_b32 s64, s52, 11
  s_add_u32 s64, s64, 87040
  v_lshrrev_b32 v230, 4, v0
  v_lshlrev_b32 v230, 9, v230
  v_add_u32 v230, s64, v230
  v_lshl_add_u32 v228, v228, 4, v230
  v_lshl_add_u32 v229, v229, 4, v230
  s_add_u32 s64, s64, 9216
  v_add_u32 v231, s64, v1
  v_add_u32 v230, 16, v0
  v_lshrrev_b32 v230, 6, v230
  v_add_u32 v230, -1, v230
  v_mov_b32 v12, 0x3e8b97f6
  v_mov_b32 v224, v148
  v_mov_b32 v226, v156
  v_pk_mul_f32 v[144:145], v[144:145], v[12:13] op_sel_hi:[1,0]
  v_pk_mul_f32 v[146:147], v[146:147], v[12:13] op_sel_hi:[1,0]
  v_pk_mul_f32 v[148:149], v[148:149], v[12:13] op_sel_hi:[1,0]
  v_pk_mul_f32 v[150:151], v[150:151], v[12:13] op_sel_hi:[1,0]
  v_pk_mul_f32 v[152:153], v[152:153], v[12:13] op_sel_hi:[1,0]
  v_pk_mul_f32 v[154:155], v[154:155], v[12:13] op_sel_hi:[1,0]
  v_pk_mul_f32 v[156:157], v[156:157], v[12:13] op_sel_hi:[1,0]
  v_pk_mul_f32 v[158:159], v[158:159], v[12:13] op_sel_hi:[1,0]
  v_cvt_pk_bf16_f32 v208, v144, v145
  v_cvt_pk_bf16_f32 v209, v146, v147
  v_cvt_pk_bf16_f32 v210, v148, v149
  v_cvt_pk_bf16_f32 v211, v150, v151
  v_cvt_pk_bf16_f32 v212, v152, v153
  v_cvt_pk_bf16_f32 v213, v154, v155
  v_cvt_pk_bf16_f32 v214, v156, v157
  v_cvt_pk_bf16_f32 v215, v158, v159
  v_and_b32 v210, v230, v210
  v_and_b32 v211, v230, v211
  v_and_b32 v214, v230, v214
  v_and_b32 v215, v230, v215
  ds_write_b128 v228, v[208:211]
  ds_write_b128 v229, v[212:215]
  v_cvt_pk_bf16_f32 v224, v224, v224
  v_cvt_pk_bf16_f32 v226, v226, v226
  v_lshlrev_b32 v224, 16, v224
  v_lshlrev_b32 v226, 16, v226
  v_mul_f32 v224, 0xbfb8aa3b, v224
  v_mul_f32 v226, 0xbfb8aa3b, v226
  v_exp_f32 v224, v224
  v_exp_f32 v226, v226
  v_add_f32 v224, 1.0, v224
  v_add_f32 v226, 1.0, v226
  v_rcp_f32 v224, v224
  v_rcp_f32 v226, v226
  v_cvt_pk_bf16_f32 v224, v224, v224
  v_cvt_pk_bf16_f32 v226, v226, v226
  v_lshlrev_b32 v224, 16, v224
  v_lshlrev_b32 v226, 16, v226
  v_sub_f32 v225, 1.0, v224
  v_sub_f32 v227, 1.0, v226
  v_cvt_pk_bf16_f32 v225, v225, v225
  v_cvt_pk_bf16_f32 v227, v227, v227
  v_lshlrev_b32 v225, 16, v225
  v_lshlrev_b32 v227, 16, v227
  s_mov_b32 exec_lo, 0
  s_mov_b32 exec_hi, 0xffff0000
  ds_write_b64 v246, v[224:225]
  ds_write_b64 v247, v[226:227]
  s_mov_b64 exec, -1
  s_mov_b64 exec, 1
  ds_add_u32 v255, v5 offset:44
  s_mov_b64 exec, -1
  v_add_u32 v14, 4294919168, v14
  v_add_u32 v9, 4294919168, v9
  s_mul_i32 s65, s51, 24576
  s_add_u32 s65, s65, 114688
  v_add_u32 v133, s65, v1
  v_bfe_u32 v132, v0, 2, 2
  v_lshlrev_b32 v132, 7, v132
  v_bfe_u32 v10, v0, 4, 1
  v_lshl_add_u32 v132, v10, 5, v132
  v_and_b32 v10, 3, v0
  v_lshl_add_u32 v132, v10, 3, v132
  v_bfe_u32 v10, v0, 3, 1
  v_lshl_add_u32 v132, v10, 6, v132
  s_mul_i32 s65, s52, 14336
  s_add_u32 s65, s65, 58368
  v_add_u32 v130, s65, v132
  v_xor_b32 v131, 64, v130
  v_lshrrev_b32 v10, 5, v0
  v_lshl_add_u32 v128, v10, 9, v130
  v_lshl_add_u32 v129, v10, 9, v131
  v_mul_u32_u24 v132, 896, v7
  v_lshl_add_u32 v132, v10, 4, v132
  v_mov_b32 v140, -1
  v_mov_b32 v232, 0
  v_mov_b32 v141, -1
  v_mov_b32 v233, 0
  v_mov_b32 v142, -1
  v_mov_b32 v234, 0
  v_mov_b32 v143, -1
  v_mov_b32 v235, 0
  s_lshr_b32 s65, s2, 3
  s_lshl_b32 s65, s65, 2
  s_add_u32 s65, s65, s52
  s_mul_i32 s65, s65, 3136
  v_min_u32 v4, 24, v0
  v_lshl_add_u32 v4, v4, 7, s65
  s_lshl_b32 s64, s52, 12
  s_add_u32 s64, s64, 114688
  v_add_u32 v2, s64, v1
  s_sub_i32 s65, s49, 2
  s_max_i32 s65, s65, 0
  v_and_b32 v236, 15, v0
  v_max_u32 v236, s65, v236
  v_min_u32 v236, s49, v236
  v_bfe_u32 v10, v0, 4, 1
  v_lshl_add_u32 v236, v10, 6, v236
  v_lshlrev_b32 v236, 7, v236
  s_mul_i32 s11, s52, 12288
  s_lshl_b32 s64, s49, 14
  s_sub_u32 s64, s64, 32768
  s_add_u32 s64, s64, s11
  v_add_u32 v237, s64, v1
  s_and_b32 s64, s52, 2
  s_lshl_b32 s65, s64, 11
  s_add_u32 s65, s65, 87040
  v_add_u32 v238, s65, v1
  s_lshl_b32 s64, s64, 8
  s_add_u32 s64, s64, 95232
  v_lshl_add_u32 v239, v7, 3, s64
  s_lshl_b32 s64, s52, 8
  s_add_u32 s64, s64, 95232
  v_lshl_add_u32 v8, v7, 3, s64
  s_waitcnt lgkmcnt(0)
  v_or_b32 v246, s9, v15
  v_mov_b32 v247, 0x2b800000
  s_mov_b32 s3, 1600000
L_cw_20:
  ds_read_b32 v13, v255 offset:40
  s_waitcnt lgkmcnt(0)
  v_cmp_gt_u32 vcc, 4, v13
  s_cbranch_vccz L_cw_done_21
  s_sleep 1
  s_sub_u32 s3, s3, 1
  s_cbranch_scc0 L_cw_20
L_cw_done_21:
  s_setprio 3
  ds_read_b64_tr_b16 v[160:161], v14 offset:0
  ds_read_b64_tr_b16 v[162:163], v14 offset:256
  ds_read_b64_tr_b16 v[164:165], v9 offset:0
  ds_read_b64_tr_b16 v[166:167], v9 offset:256
  ds_read_b64_tr_b16 v[168:169], v14 offset:2048
  ds_read_b64_tr_b16 v[170:171], v14 offset:2304
  ds_read_b64_tr_b16 v[172:173], v9 offset:2048
  ds_read_b64_tr_b16 v[174:175], v9 offset:2304
  ds_read_b64_tr_b16 v[176:177], v14 offset:4096
  ds_read_b64_tr_b16 v[178:179], v14 offset:4352
  ds_read_b64_tr_b16 v[180:181], v9 offset:4096
  ds_read_b64_tr_b16 v[182:183], v9 offset:4352
  s_waitcnt lgkmcnt(8)
  v_mfma_f32_16x16x32_bf16 v[144:147], v[160:163], v[16:19], 0
  ds_read_b64_tr_b16 v[184:185], v14 offset:6144
  v_mfma_f32_16x16x32_bf16 v[148:151], v[164:167], v[16:19], 0
  ds_read_b64_tr_b16 v[186:187], v14 offset:6400
  v_mfma_f32_16x16x32_bf16 v[152:155], v[160:163], v[20:23], 0
  ds_read_b64_tr_b16 v[188:189], v9 offset:6144
  v_mfma_f32_16x16x32_bf16 v[156:159], v[164:167], v[20:23], 0
  ds_read_b64_tr_b16 v[190:191], v9 offset:6400
  s_waitcnt lgkmcnt(8)
  v_mfma_f32_16x16x32_bf16 v[144:147], v[168:171], v[24:27], v[144:147]
  ds_read_b64_tr_b16 v[160:161], v14 offset:8192
  v_mfma_f32_16x16x32_bf16 v[148:151], v[172:175], v[24:27], v[148:151]
  ds_read_b64_tr_b16 v[162:163], v14 offset:8448
  v_mfma_f32_16x16x32_bf16 v[152:155], v[168:171], v[28:31], v[152:155]
  ds_read_b64_tr_b16 v[164:165], v9 offset:8192
  v_mfma_f32_16x16x32_bf16 v[156:159], v[172:175], v[28:31], v[156:159]
  ds_read_b64_tr_b16 v[166:167], v9 offset:8448
  s_waitcnt lgkmcnt(8)
  v_mfma_f32_16x16x32_bf16 v[144:147], v[176:179], v[32:35], v[144:147]
  ds_read_b64_tr_b16 v[168:169], v14 offset:10240
  v_mfma_f32_16x16x32_bf16 v[148:151], v[180:183], v[32:35], v[148:151]
  ds_read_b64_tr_b16 v[170:171], v14 offset:10496
  v_mfma_f32_16x16x32_bf16 v[152:155], v[176:179], v[36:39], v[152:155]
  ds_read_b64_tr_b16 v[172:173], v9 offset:10240
  v_mfma_f32_16x16x32_bf16 v[156:159], v[180:183], v[36:39], v[156:159]
  ds_read_b64_tr_b16 v[174:175], v9 offset:10496
  s_waitcnt lgkmcnt(8)
  v_mfma_f32_16x16x32_bf16 v[144:147], v[184:187], v[40:43], v[144:147]
  ds_read_b64_tr_b16 v[176:177], v14 offset:12288
  v_mfma_f32_16x16x32_bf16 v[148:151], v[188:191], v[40:43], v[148:151]
  ds_read_b64_tr_b16 v[178:179], v14 offset:12544
  v_mfma_f32_16x16x32_bf16 v[152:155], v[184:187], v[44:47], v[152:155]
  ds_read_b64_tr_b16 v[180:181], v9 offset:12288
  v_mfma_f32_16x16x32_bf16 v[156:159], v[188:191], v[44:47], v[156:159]
  ds_read_b64_tr_b16 v[182:183], v9 offset:12544
  s_waitcnt lgkmcnt(8)
  v_mfma_f32_16x16x32_bf16 v[144:147], v[160:163], v[48:51], v[144:147]
  ds_read_b64_tr_b16 v[184:185], v14 offset:14336
  v_mfma_f32_16x16x32_bf16 v[148:151], v[164:167], v[48:51], v[148:151]
  ds_read_b64_tr_b16 v[186:187], v14 offset:14592
  v_mfma_f32_16x16x32_bf16 v[152:155], v[160:163], v[52:55], v[152:155]
  ds_read_b64_tr_b16 v[188:189], v9 offset:14336
  v_mfma_f32_16x16x32_bf16 v[156:159], v[164:167], v[52:55], v[156:159]
  ds_read_b64_tr_b16 v[190:191], v9 offset:14592
  s_waitcnt lgkmcnt(8)
  v_mfma_f32_16x16x32_bf16 v[144:147], v[168:171], v[56:59], v[144:147]
  ds_read_b64_tr_b16 v[160:161], v14 offset:16384
  v_mfma_f32_16x16x32_bf16 v[148:151], v[172:175], v[56:59], v[148:151]
  ds_read_b64_tr_b16 v[162:163], v14 offset:16640
  v_mfma_f32_16x16x32_bf16 v[152:155], v[168:171], v[60:63], v[152:155]
  ds_read_b64_tr_b16 v[164:165], v9 offset:16384
  v_mfma_f32_16x16x32_bf16 v[156:159], v[172:175], v[60:63], v[156:159]
  ds_read_b64_tr_b16 v[166:167], v9 offset:16640
  s_waitcnt lgkmcnt(8)
  v_mfma_f32_16x16x32_bf16 v[144:147], v[176:179], v[64:67], v[144:147]
  ds_read_b64_tr_b16 v[168:169], v14 offset:18432
  v_mfma_f32_16x16x32_bf16 v[148:151], v[180:183], v[64:67], v[148:151]
  ds_read_b64_tr_b16 v[170:171], v14 offset:18688
  v_mfma_f32_16x16x32_bf16 v[152:155], v[176:179], v[68:71], v[152:155]
  ds_read_b64_tr_b16 v[172:173], v9 offset:18432
  v_mfma_f32_16x16x32_bf16 v[156:159], v[180:183], v[68:71], v[156:159]
  ds_read_b64_tr_b16 v[174:175], v9 offset:18688
  s_waitcnt lgkmcnt(8)
  v_mfma_f32_16x16x32_bf16 v[144:147], v[184:187], v[72:75], v[144:147]
  ds_read_b64_tr_b16 v[176:177], v14 offset:20480
  v_mfma_f32_16x16x32_bf16 v[148:151], v[188:191], v[72:75], v[148:151]
  ds_read_b64_tr_b16 v[178:179], v14 offset:20736
  v_mfma_f32_16x16x32_bf16 v[152:155], v[184:187], v[76:79], v[152:155]
  ds_read_b64_tr_b16 v[180:181], v9 offset:20480
  v_mfma_f32_16x16x32_bf16 v[156:159], v[188:191], v[76:79], v[156:159]
  ds_read_b64_tr_b16 v[182:183], v9 offset:20736
  s_waitcnt lgkmcnt(8)
  v_mfma_f32_16x16x32_bf16 v[144:147], v[160:163], v[80:83], v[144:147]
  ds_read_b64_tr_b16 v[184:185], v14 offset:22528
  v_mfma_f32_16x16x32_bf16 v[148:151], v[164:167], v[80:83], v[148:151]
  ds_read_b64_tr_b16 v[186:187], v14 offset:22784
  v_mfma_f32_16x16x32_bf16 v[152:155], v[160:163], v[84:87], v[152:155]
  ds_read_b64_tr_b16 v[188:189], v9 offset:22528
  v_mfma_f32_16x16x32_bf16 v[156:159], v[164:167], v[84:87], v[156:159]
  ds_read_b64_tr_b16 v[190:191], v9 offset:22784
  s_waitcnt lgkmcnt(8)
  v_mfma_f32_16x16x32_bf16 v[144:147], v[168:171], v[88:91], v[144:147]
  ds_read_b64_tr_b16 v[160:161], v14 offset:24576
  v_mfma_f32_16x16x32_bf16 v[148:151], v[172:175], v[88:91], v[148:151]
  ds_read_b64_tr_b16 v[162:163], v14 offset:24832
  v_mfma_f32_16x16x32_bf16 v[152:155], v[168:171], v[92:95], v[152:155]
  ds_read_b64_tr_b16 v[164:165], v9 offset:24576
  v_mfma_f32_16x16x32_bf16 v[156:159], v[172:175], v[92:95], v[156:159]
  ds_read_b64_tr_b16 v[166:167], v9 offset:24832
  s_waitcnt lgkmcnt(8)
  v_mfma_f32_16x16x32_bf16 v[144:147], v[176:179], v[96:99], v[144:147]
  ds_read_b64_tr_b16 v[168:169], v14 offset:26624
  v_mfma_f32_16x16x32_bf16 v[148:151], v[180:183], v[96:99], v[148:151]
  ds_read_b64_tr_b16 v[170:171], v14 offset:26880
  v_mfma_f32_16x16x32_bf16 v[152:155], v[176:179], v[100:103], v[152:155]
  ds_read_b64_tr_b16 v[172:173], v9 offset:26624
  v_mfma_f32_16x16x32_bf16 v[156:159], v[180:183], v[100:103], v[156:159]
  ds_read_b64_tr_b16 v[174:175], v9 offset:26880
  s_waitcnt lgkmcnt(8)
  v_mfma_f32_16x16x32_bf16 v[144:147], v[184:187], v[104:107], v[144:147]
  v_mfma_f32_16x16x32_bf16 v[148:151], v[188:191], v[104:107], v[148:151]
  v_mfma_f32_16x16x32_bf16 v[152:155], v[184:187], v[108:111], v[152:155]
  v_mfma_f32_16x16x32_bf16 v[156:159], v[188:191], v[108:111], v[156:159]
  s_waitcnt lgkmcnt(4)
  v_mfma_f32_16x16x32_bf16 v[144:147], v[160:163], v[112:115], v[144:147]
  v_mfma_f32_16x16x32_bf16 v[148:151], v[164:167], v[112:115], v[148:151]
  v_mfma_f32_16x16x32_bf16 v[152:155], v[160:163], v[116:119], v[152:155]
  v_mfma_f32_16x16x32_bf16 v[156:159], v[164:167], v[116:119], v[156:159]
  s_waitcnt lgkmcnt(0)
  v_mfma_f32_16x16x32_bf16 v[144:147], v[168:171], v[120:123], v[144:147]
  v_mfma_f32_16x16x32_bf16 v[148:151], v[172:175], v[120:123], v[148:151]
  v_mfma_f32_16x16x32_bf16 v[152:155], v[168:171], v[124:127], v[152:155]
  v_mfma_f32_16x16x32_bf16 v[156:159], v[172:175], v[124:127], v[156:159]
  s_setprio 3
  v_mfma_f32_32x32x16_bf16 v[88:103], v[232:235], v[232:235], 0
  s_nop 6
  v_pk_mul_f32 v[144:145], v[144:145], v[12:13] op_sel_hi:[1,0]
  v_pk_mul_f32 v[146:147], v[146:147], v[12:13] op_sel_hi:[1,0]
  v_pk_mul_f32 v[148:149], v[148:149], v[12:13] op_sel_hi:[1,0]
  v_pk_mul_f32 v[150:151], v[150:151], v[12:13] op_sel_hi:[1,0]
  v_pk_mul_f32 v[152:153], v[152:153], v[12:13] op_sel_hi:[1,0]
  v_pk_mul_f32 v[154:155], v[154:155], v[12:13] op_sel_hi:[1,0]
  v_pk_mul_f32 v[156:157], v[156:157], v[12:13] op_sel_hi:[1,0]
  v_pk_mul_f32 v[158:159], v[158:159], v[12:13] op_sel_hi:[1,0]
  v_cvt_pk_bf16_f32 v208, v144, v145
  v_cvt_pk_bf16_f32 v209, v146, v147
  v_cvt_pk_bf16_f32 v210, v148, v149
  v_cvt_pk_bf16_f32 v211, v150, v151
  v_cvt_pk_bf16_f32 v212, v152, v153
  v_cvt_pk_bf16_f32 v213, v154, v155
  v_cvt_pk_bf16_f32 v214, v156, v157
  v_cvt_pk_bf16_f32 v215, v158, v159
  v_and_b32 v210, v230, v210
  v_and_b32 v211, v230, v211
  v_and_b32 v214, v230, v214
  v_and_b32 v215, v230, v215
  ds_write_b128 v228, v[208:211] offset:9216
  ds_write_b128 v229, v[212:215] offset:9216
  ds_read_b128 v[16:19], v231 offset:0
  ds_read_b128 v[20:23], v231 offset:1024
  s_mov_b32 s3, 1600000
L_cw_22:
  ds_read_b32 v13, v255 offset:44
  s_waitcnt lgkmcnt(0)
  v_cmp_gt_u32 vcc, 4, v13
  s_cbranch_vccz L_cw_done_23
  s_sleep 1
  s_sub_u32 s3, s3, 1
  s_cbranch_scc0 L_cw_22
L_cw_done_23:
  ds_read_b128 v[24:27], v238 offset:0
  ds_read_b128 v[28:31], v238 offset:1024
  ds_read_b128 v[32:35], v238 offset:2048
  ds_read_b128 v[36:39], v238 offset:3072
  ds_read_b32 v9, v239 offset:4
  ds_read_b32 v136, v239 offset:260
  ds_read_b32 v8, v8
  ds_read_b128 v[104:107], v1 offset:1024
  ds_read_b128 v[108:111], v1 offset:2048
  ds_read_b128 v[112:115], v1 offset:3072
  ds_read_b128 v[116:119], v1 offset:4096
  ds_read_b128 v[160:163], v1 offset:5120
  ds_read_b128 v[164:167], v1 offset:6144
  ds_read_b128 v[168:171], v1 offset:7168
  ds_read_b128 v[172:175], v1 offset:8192
  s_mov_b32 s3, 1600000
L_cw_24:
  ds_read_b32 v13, v255 offset:4
  s_waitcnt lgkmcnt(0)
  v_cmp_gt_u32 vcc, 4, v13
  s_cbranch_vccz L_cw_done_25
  s_sleep 1
  s_sub_u32 s3, s3, 1
  s_cbranch_scc0 L_cw_24
L_cw_done_25:
  s_cmp_lt_u32 s53, 8
  s_cbranch_scc0 L_h_b
  buffer_store_dwordx4 v[248:251], v240, s[24:27], s10 offen sc1
  buffer_store_dwordx4 v[242:245], v240, s[24:27], s10 offen offset:256 sc1
  buffer_store_dwordx4 v[192:195], v240, s[24:27], s12 offen sc1
  buffer_store_dwordx4 v[196:199], v240, s[24:27], s12 offen offset:256 sc1
  buffer_store_dwordx4 v[216:219], v240, s[24:27], s13 offen sc1
  buffer_store_dwordx4 v[220:223], v240, s[24:27], s13 offen offset:256 sc1
  buffer_store_dwordx4 v[200:203], v240, s[24:27], s14 offen sc1
  buffer_store_dwordx4 v[204:207], v240, s[24:27], s14 offen offset:256 sc1
  s_waitcnt vmcnt(0)
  s_mov_b64 exec, 1
  ds_add_rtn_u32 v11, v255, v5 offset:0
  s_waitcnt lgkmcnt(0)
  v_cmp_eq_u32 vcc, 3, v11
  s_cbranch_vccz L_nosig_26
  buffer_store_dwordx2 v[252:253], v255, s[24:27], s19 offen sc1
L_nosig_26:
  s_mov_b64 exec, -1
L_h_b:
  v_mov_b32 v240, v128
  v_mov_b32 v241, v129
  v_mov_b32 v242, v130
  v_mov_b32 v243, v131
  v_mov_b32 v244, v132
  v_mov_b32 v245, v133
  v_mov_b32 v248, v136
  v_mov_b32 v10, v237
  s_mov_b32 s3, 200000
L_poll_27:
  buffer_load_dwordx2 v[12:13], v236, s[24:27], s18 offen sc1
  s_waitcnt vmcnt(0)
  v_cmp_eq_u64 vcc, s[54:55], v[12:13]
  s_cmp_eq_u64 vcc, -1
  s_cbranch_scc1 L_poll_done_28
  s_sleep 8
  s_sub_u32 s3, s3, 1
  s_cbranch_scc0 L_poll_27
L_poll_done_28:
  s_add_u32 m0, s11, 114688
  s_nop 0
  buffer_load_dwordx4 v10, s[28:31], 0 offen offset:0 sc1 lds
  s_waitcnt vmcnt(5)
  buffer_load_dwordx4 v10, s[28:31], 0 offen offset:1024 sc1 lds
  s_waitcnt vmcnt(5)
  buffer_load_dwordx4 v10, s[28:31], 0 offen offset:2048 sc1 lds
  s_waitcnt vmcnt(5)
  buffer_load_dwordx4 v10, s[28:31], 0 offen offset:3072 sc1 lds
  s_waitcnt vmcnt(5)
  v_add_u32 v10, 4096, v10
  s_add_u32 m0, s11, 118784
  s_nop 0
  buffer_load_dwordx4 v10, s[28:31], 0 offen offset:0 sc1 lds
  s_waitcnt vmcnt(5)
  buffer_load_dwordx4 v10, s[28:31], 0 offen offset:1024 sc1 lds
  s_waitcnt vmcnt(5)
  buffer_load_dwordx4 v10, s[28:31], 0 offen offset:2048 sc1 lds
  s_waitcnt vmcnt(5)
  buffer_load_dwordx4 v10, s[28:31], 0 offen offset:3072 sc1 lds
  s_waitcnt vmcnt(5)
  v_add_u32 v10, 4096, v10
  s_add_u32 m0, s11, 122880
  s_nop 0
  buffer_load_dwordx4 v10, s[28:31], 0 offen offset:0 sc1 lds
  s_waitcnt vmcnt(5)
  buffer_load_dwordx4 v10, s[28:31], 0 offen offset:1024 sc1 lds
  s_waitcnt vmcnt(5)
  buffer_load_dwordx4 v10, s[28:31], 0 offen offset:2048 sc1 lds
  s_waitcnt vmcnt(5)
  buffer_load_dwordx4 v10, s[28:31], 0 offen offset:3072 sc1 lds
  s_waitcnt vmcnt(5)
  v_add_u32 v10, 4096, v10
  s_waitcnt vmcnt(0)
  s_mov_b64 exec, 1
  ds_add_u32 v255, v5 offset:12
  s_mov_b64 exec, -1
  buffer_load_dword v137, v4, s[36:39], 0 offen
  buffer_load_dword v138, v4, s[32:35], 0 offen
  s_mov_b32 s3, 1600000
L_cw_29:
  ds_read_b32 v13, v255 offset:12
  s_waitcnt lgkmcnt(0)
  v_cmp_gt_u32 vcc, 4, v13
  s_cbranch_vccz L_cw_done_30
  s_sleep 1
  s_sub_u32 s3, s3, 1
  s_cbranch_scc0 L_cw_29
L_cw_done_30:
  ds_read_b128 v[40:43], v2 offset:0
  ds_read_b128 v[44:47], v2 offset:1024
  ds_read_b128 v[48:51], v2 offset:2048
  ds_read_b128 v[52:55], v2 offset:3072
  s_waitcnt lgkmcnt(3)
  v_mfma_f32_32x32x16_bf16 v[56:71], v[40:43], v[16:19], v[104:119]
  ds_read_b128 v[40:43], v2 offset:4096
  s_waitcnt lgkmcnt(3)
  v_mfma_f32_32x32x16_bf16 v[56:71], v[44:47], v[20:23], v[56:71]
  ds_read_b128 v[44:47], v2 offset:5120
  s_nop 10
  s_setprio 3
  v_exp_f32 v56, v56
  v_exp_f32 v57, v57
  v_exp_f32 v58, v58
  v_exp_f32 v59, v59
  v_exp_f32 v60, v60
  s_waitcnt lgkmcnt(1)
  v_mfma_f32_32x32x16_bf16 v[72:87], v[40:43], v[16:19], 0
  ds_read_b128 v[40:43], v2 offset:8192
  v_exp_f32 v61, v61
  v_exp_f32 v62, v62
  v_exp_f32 v63, v63
  s_waitcnt lgkmcnt(1)
  v_mfma_f32_32x32x16_bf16 v[72:87], v[44:47], v[20:23], v[72:87]
  ds_read_b128 v[44:47], v2 offset:9216
  v_exp_f32 v64, v64
  v_exp_f32 v65, v65
  v_exp_f32 v66, v66
  v_exp_f32 v67, v67
  v_smfmac_f32_32x32x32_bf16 v[88:103], v[48:51], v[56:63], v6
  ds_read_b128 v[48:51], v2 offset:6144
  v_exp_f32 v68, v68
  v_exp_f32 v69, v69
  v_exp_f32 v70, v70
  v_exp_f32 v71, v71
  v_exp_f32 v72, v72
  v_exp_f32 v73, v73
  v_smfmac_f32_32x32x32_bf16 v[88:103], v[52:55], v[64:71], v6
  ds_read_b128 v[52:55], v2 offset:7168
  v_exp_f32 v74, v74
  v_exp_f32 v75, v75
  v_exp_f32 v76, v76
  s_waitcnt lgkmcnt(3)
  v_mfma_f32_32x32x16_bf16 v[56:71], v[40:43], v[16:19], 0
  ds_read_b128 v[40:43], v2 offset:12288
  v_exp_f32 v77, v77
  v_exp_f32 v78, v78
  v_exp_f32 v79, v79
  s_waitcnt lgkmcnt(3)
  v_mfma_f32_32x32x16_bf16 v[56:71], v[44:47], v[20:23], v[56:71]
  ds_read_b128 v[44:47], v2 offset:13312
  v_exp_f32 v80, v80
  s_add_u32 s64, s60, 32768
  buffer_store_dwordx4 v[140:143], v1, s[24:27], s64 offen offset:0 sc1
  v_exp_f32 v81, v81
  v_exp_f32 v82, v82
  v_exp_f32 v83, v83
  s_waitcnt lgkmcnt(3)
  v_smfmac_f32_32x32x32_bf16 v[88:103], v[48:51], v[72:79], v6
  ds_read_b128 v[48:51], v2 offset:10240
  v_exp_f32 v84, v84
  v_exp_f32 v85, v85
  v_exp_f32 v86, v86
  v_exp_f32 v87, v87
  v_exp_f32 v56, v56
  v_exp_f32 v57, v57
  s_waitcnt lgkmcnt(3)
  v_smfmac_f32_32x32x32_bf16 v[88:103], v[52:55], v[80:87], v6
  ds_read_b128 v[52:55], v2 offset:11264
  v_exp_f32 v58, v58
  v_exp_f32 v59, v59
  v_exp_f32 v60, v60
  s_waitcnt lgkmcnt(3)
  v_mfma_f32_32x32x16_bf16 v[72:87], v[40:43], v[16:19], 0
  ds_read_b128 v[40:43], v2 offset:16384
  v_exp_f32 v61, v61
  v_exp_f32 v62, v62
  v_exp_f32 v63, v63
  s_waitcnt lgkmcnt(3)
  v_mfma_f32_32x32x16_bf16 v[72:87], v[44:47], v[20:23], v[72:87]
  ds_read_b128 v[44:47], v2 offset:17408
  v_exp_f32 v64, v64
  v_exp_f32 v65, v65
  v_exp_f32 v66, v66
  v_exp_f32 v67, v67
  s_waitcnt lgkmcnt(3)
  v_smfmac_f32_32x32x32_bf16 v[88:103], v[48:51], v[56:63], v6
  ds_read_b128 v[48:51], v2 offset:14336
  v_exp_f32 v68, v68
  v_exp_f32 v69, v69
  v_exp_f32 v70, v70
  v_exp_f32 v71, v71
  v_exp_f32 v72, v72
  v_exp_f32 v73, v73
  s_waitcnt lgkmcnt(3)
  v_smfmac_f32_32x32x32_bf16 v[88:103], v[52:55], v[64:71], v6
  ds_read_b128 v[52:55], v2 offset:15360
  v_exp_f32 v74, v74
  v_exp_f32 v75, v75
  v_exp_f32 v76, v76
  s_waitcnt lgkmcnt(3)
  v_mfma_f32_32x32x16_bf16 v[56:71], v[40:43], v[16:19], 0
  ds_read_b128 v[40:43], v2 offset:20480
  v_exp_f32 v77, v77
  v_exp_f32 v78, v78
  v_exp_f32 v79, v79
  s_waitcnt lgkmcnt(3)
  v_mfma_f32_32x32x16_bf16 v[56:71], v[44:47], v[20:23], v[56:71]
  ds_read_b128 v[44:47], v2 offset:21504
  v_exp_f32 v80, v80
  s_add_u32 s64, s60, 32768
  buffer_store_dwordx4 v[140:143], v1, s[24:27], s64 offen offset:1024 sc1
  v_exp_f32 v81, v81
  v_exp_f32 v82, v82
  v_exp_f32 v83, v83
  s_waitcnt lgkmcnt(3)
  v_smfmac_f32_32x32x32_bf16 v[88:103], v[48:51], v[72:79], v6
  ds_read_b128 v[48:51], v2 offset:18432
  v_exp_f32 v84, v84
  v_exp_f32 v85, v85
  v_exp_f32 v86, v86
  v_exp_f32 v87, v87
  v_exp_f32 v56, v56
  v_exp_f32 v57, v57
  s_waitcnt lgkmcnt(3)
  v_smfmac_f32_32x32x32_bf16 v[88:103], v[52:55], v[80:87], v6
  ds_read_b128 v[52:55], v2 offset:19456
  v_exp_f32 v58, v58
  v_exp_f32 v59, v59
  v_exp_f32 v60, v60
  s_waitcnt lgkmcnt(3)
  v_mfma_f32_32x32x16_bf16 v[72:87], v[40:43], v[16:19], 0
  ds_read_b128 v[40:43], v2 offset:24576
  v_exp_f32 v61, v61
  v_exp_f32 v62, v62
  v_exp_f32 v63, v63
  s_waitcnt lgkmcnt(3)
  v_mfma_f32_32x32x16_bf16 v[72:87], v[44:47], v[20:23], v[72:87]
  ds_read_b128 v[44:47], v2 offset:25600
  v_exp_f32 v64, v64
  v_exp_f32 v65, v65
  v_exp_f32 v66, v66
  v_exp_f32 v67, v67
  s_waitcnt lgkmcnt(3)
  v_smfmac_f32_32x32x32_bf16 v[88:103], v[48:51], v[56:63], v6
  ds_read_b128 v[48:51], v2 offset:22528
  v_exp_f32 v68, v68
  v_exp_f32 v69, v69
  v_exp_f32 v70, v70
  v_exp_f32 v71, v71
  v_exp_f32 v72, v72
  v_exp_f32 v73, v73
  s_waitcnt lgkmcnt(3)
  v_smfmac_f32_32x32x32_bf16 v[88:103], v[52:55], v[64:71], v6
  ds_read_b128 v[52:55], v2 offset:23552
  v_exp_f32 v74, v74
  s_add_u32 m0, s7, 1024
  s_mov_b32 s65, 0
  buffer_load_dwordx4 v254, s[36:39], s65 offen lds
  v_exp_f32 v75, v75
  v_exp_f32 v76, v76
  s_waitcnt lgkmcnt(3)
  v_mfma_f32_32x32x16_bf16 v[56:71], v[40:43], v[16:19], 0
  ds_read_b128 v[40:43], v2 offset:28672
  v_exp_f32 v77, v77
  v_exp_f32 v78, v78
  v_exp_f32 v79, v79
  s_waitcnt lgkmcnt(3)
  v_mfma_f32_32x32x16_bf16 v[56:71], v[44:47], v[20:23], v[56:71]
  ds_read_b128 v[44:47], v2 offset:29696
  v_exp_f32 v80, v80
  s_add_u32 m0, s7, 5120
  s_mov_b32 s65, 28672
  buffer_load_dwordx4 v254, s[36:39], s65 offen lds
  v_exp_f32 v81, v81
  v_exp_f32 v82, v82
  v_exp_f32 v83, v83
  s_waitcnt lgkmcnt(3)
  v_smfmac_f32_32x32x32_bf16 v[88:103], v[48:51], v[72:79], v6
  ds_read_b128 v[48:51], v2 offset:26624
  v_exp_f32 v84, v84
  v_exp_f32 v85, v85
  s_add_u32 m0, s7, 9216
  s_mov_b32 s65, 57344
  buffer_load_dwordx4 v254, s[36:39], s65 offen lds
  v_exp_f32 v86, v86
  v_exp_f32 v87, v87
  v_exp_f32 v56, v56
  v_exp_f32 v57, v57
  s_waitcnt lgkmcnt(3)
  v_smfmac_f32_32x32x32_bf16 v[88:103], v[52:55], v[80:87], v6
  ds_read_b128 v[52:55], v2 offset:27648
  v_exp_f32 v58, v58
  s_add_u32 m0, s7, 13312
  s_mov_b32 s65, 86016
  buffer_load_dwordx4 v254, s[36:39], s65 offen lds
  v_exp_f32 v59, v59
  v_exp_f32 v60, v60
  s_waitcnt lgkmcnt(3)
  v_mfma_f32_32x32x16_bf16 v[72:87], v[40:43], v[16:19], 0
  ds_read_b128 v[40:43], v2 offset:32768
  v_exp_f32 v61, v61
  v_exp_f32 v62, v62
  v_exp_f32 v63, v63
  s_waitcnt lgkmcnt(3)
  v_mfma_f32_32x32x16_bf16 v[72:87], v[44:47], v[20:23], v[72:87]
  ds_read_b128 v[44:47], v2 offset:33792
  v_exp_f32 v64, v64
  s_add_u32 m0, s7, 17408
  s_mov_b32 s65, 114688
  buffer_load_dwordx4 v254, s[36:39], s65 offen lds
  v_exp_f32 v65, v65
  v_exp_f32 v66, v66
  v_exp_f32 v67, v67
  s_waitcnt lgkmcnt(3)
  v_smfmac_f32_32x32x32_bf16 v[88:103], v[48:51], v[56:63], v6
  ds_read_b128 v[48:51], v2 offset:30720
  v_exp_f32 v68, v68
  v_exp_f32 v69, v69
  s_add_u32 m0, s7, 21504
  s_mov_b32 s65, 143360
  buffer_load_dwordx4 v254, s[36:39], s65 offen lds
  v_exp_f32 v70, v70
  v_exp_f32 v71, v71
  v_exp_f32 v72, v72
  v_exp_f32 v73, v73
  s_waitcnt lgkmcnt(3)
  v_smfmac_f32_32x32x32_bf16 v[88:103], v[52:55], v[64:71], v6
  ds_read_b128 v[52:55], v2 offset:31744
  v_exp_f32 v74, v74
  s_add_u32 m0, s7, 25600
  s_mov_b32 s65, 172032
  buffer_load_dwordx4 v254, s[36:39], s65 offen lds
  v_exp_f32 v75, v75
  v_exp_f32 v76, v76
  s_waitcnt lgkmcnt(3)
  v_mfma_f32_32x32x16_bf16 v[56:71], v[40:43], v[16:19], v[160:175]
  v_exp_f32 v77, v77
  v_exp_f32 v78, v78
  v_exp_f32 v79, v79
  s_waitcnt lgkmcnt(2)
  v_mfma_f32_32x32x16_bf16 v[56:71], v[44:47], v[20:23], v[56:71]
  v_exp_f32 v80, v80
  s_add_u32 m0, s7, 29696
  s_mov_b32 s65, 200704
  buffer_load_dwordx4 v254, s[36:39], s65 offen lds
  v_exp_f32 v81, v81
  v_exp_f32 v82, v82
  v_exp_f32 v83, v83
  s_waitcnt lgkmcnt(1)
  v_smfmac_f32_32x32x32_bf16 v[88:103], v[48:51], v[72:79], v6
  ds_read_b128 v[48:51], v2 offset:34816
  v_exp_f32 v84, v84
  v_exp_f32 v85, v85
  s_add_u32 m0, s7, 33792
  s_mov_b32 s65, 229376
  buffer_load_dwordx4 v254, s[36:39], s65 offen lds
  v_exp_f32 v86, v86
  v_exp_f32 v87, v87
  v_exp_f32 v56, v56
  v_exp_f32 v57, v57
  s_waitcnt lgkmcnt(1)
  v_smfmac_f32_32x32x32_bf16 v[88:103], v[52:55], v[80:87], v6
  ds_read_b128 v[52:55], v2 offset:35840
  v_exp_f32 v58, v58
  s_add_u32 m0, s7, 37888
  s_mov_b32 s65, 258048
  buffer_load_dwordx4 v254, s[36:39], s65 offen lds
  v_exp_f32 v59, v59
  v_exp_f32 v60, v60
  v_exp_f32 v61, v61
  v_exp_f32 v62, v62
  v_exp_f32 v63, v63
  v_exp_f32 v64, v64
  s_add_u32 m0, s7, 41984
  s_mov_b32 s65, 286720
  buffer_load_dwordx4 v254, s[36:39], s65 offen lds
  v_exp_f32 v65, v65
  v_exp_f32 v66, v66
  v_exp_f32 v67, v67
  s_waitcnt lgkmcnt(1)
  v_smfmac_f32_32x32x32_bf16 v[88:103], v[48:51], v[56:63], v6
  v_exp_f32 v68, v68
  v_exp_f32 v69, v69
  s_add_u32 m0, s7, 46080
  s_mov_b32 s65, 315392
  buffer_load_dwordx4 v254, s[36:39], s65 offen lds
  v_exp_f32 v70, v70
  v_exp_f32 v71, v71
  s_nop 1
  s_waitcnt lgkmcnt(0)
  v_smfmac_f32_32x32x32_bf16 v[88:103], v[52:55], v[64:71], v6
  s_mov_b64 exec, 1
  ds_add_u32 v255, v5 offset:16
  s_mov_b64 exec, -1
  s_nop 8
  v_mov_b32 v3, v100
  v_mov_b32 v10, v100
  s_nop 1
  v_permlane32_swap_b32 v10, v3
  s_nop 0
  v_rcp_f32 v11, v3
  v_med3_f32 v12, v3, v247, s8
  v_mul_f32 v10, v11, v8
  v_pk_mul_f32 v[88:89], v[88:89], v[10:11] op_sel_hi:[1,0]
  v_pk_mul_f32 v[90:91], v[90:91], v[10:11] op_sel_hi:[1,0]
  v_pk_mul_f32 v[92:93], v[92:93], v[10:11] op_sel_hi:[1,0]
  v_pk_mul_f32 v[94:95], v[94:95], v[10:11] op_sel_hi:[1,0]
  v_pk_mul_f32 v[96:97], v[96:97], v[10:11] op_sel_hi:[1,0]
  v_pk_mul_f32 v[98:99], v[98:99], v[10:11] op_sel_hi:[1,0]
  v_pk_mul_f32 v[100:101], v[100:101], v[10:11] op_sel_hi:[1,0]
  v_pk_mul_f32 v[102:103], v[102:103], v[10:11] op_sel_hi:[1,0]
  v_mul_f32 v11, v88, v89
  v_fma_f32 v11, v90, v91, v11
  v_fma_f32 v11, v92, v93, v11
  v_fma_f32 v11, v94, v95, v11
  v_fma_f32 v11, v96, v97, v11
  v_fma_f32 v11, v98, v99, v11
  v_fma_f32 v11, v100, v101, v11
  v_fma_f32 v11, v102, v103, v11
  v_fma_f32 v11, v11, 0, v3
  v_cmp_neq_f32 vcc, v11, v12
  s_cbranch_vccnz L_slowA
L_finA:
  v_cvt_pk_bf16_f32 v88, v88, v89
  v_cvt_pk_bf16_f32 v89, v90, v91
  v_cvt_pk_bf16_f32 v90, v92, v93
  v_cvt_pk_bf16_f32 v91, v94, v95
  v_cvt_pk_bf16_f32 v92, v96, v97
  v_cvt_pk_bf16_f32 v93, v98, v99
  v_cvt_pk_bf16_f32 v94, v100, v101
  v_cvt_pk_bf16_f32 v95, v102, v103
  v_and_b32 v94, v15, v94
  v_and_b32 v95, v15, v95
  buffer_store_dwordx4 v[88:91], v1, s[24:27], s60 offen offset:0 sc1
  buffer_store_dwordx4 v[92:95], v1, s[24:27], s60 offen offset:1024 sc1
  s_waitcnt vmcnt(0)
  s_mov_b64 exec, 1
  ds_add_rtn_u32 v11, v255, v5 offset:8
  s_waitcnt lgkmcnt(0)
  v_cmp_eq_u32 vcc, 3, v11
  s_cbranch_vccz L_nosig_31
  buffer_store_dwordx2 v[252:253], v255, s[24:27], s62 offen sc1
L_nosig_31:
  s_mov_b64 exec, -1
  s_add_u32 m0, s7, 50176
  s_mov_b32 s65, 344064
  buffer_load_dwordx4 v254, s[36:39], s65 offen lds
  s_waitcnt vmcnt(4)
  s_add_u32 m0, s7, 54272
  s_mov_b32 s65, 372736
  buffer_load_dwordx4 v254, s[36:39], s65 offen lds
  s_waitcnt vmcnt(4)
  s_add_u32 m0, s7, 58368
  s_mov_b32 s65, 0
  buffer_load_dwordx4 v254, s[32:35], s65 offen lds
  s_waitcnt vmcnt(4)
  s_add_u32 m0, s7, 62464
  s_mov_b32 s65, 28672
  buffer_load_dwordx4 v254, s[32:35], s65 offen lds
  s_waitcnt vmcnt(4)
  s_add_u32 m0, s7, 66560
  s_mov_b32 s65, 57344
  buffer_load_dwordx4 v254, s[32:35], s65 offen lds
  s_waitcnt vmcnt(4)
  s_add_u32 m0, s7, 70656
  s_mov_b32 s65, 86016
  buffer_load_dwordx4 v254, s[32:35], s65 offen lds
  s_waitcnt vmcnt(4)
  s_add_u32 m0, s7, 74752
  s_mov_b32 s65, 114688
  buffer_load_dwordx4 v254, s[32:35], s65 offen lds
  s_waitcnt vmcnt(4)
  s_add_u32 m0, s7, 78848
  s_mov_b32 s65, 143360
  buffer_load_dwordx4 v254, s[32:35], s65 offen lds
  s_waitcnt vmcnt(4)
  s_add_u32 m0, s7, 82944
  s_mov_b32 s65, 172032
  buffer_load_dwordx4 v254, s[32:35], s65 offen lds
  s_waitcnt vmcnt(4)
  s_add_u32 m0, s7, 87040
  s_mov_b32 s65, 200704
  buffer_load_dwordx4 v254, s[32:35], s65 offen lds
  s_waitcnt vmcnt(4)
  s_add_u32 m0, s7, 91136
  s_mov_b32 s65, 229376
  buffer_load_dwordx4 v254, s[32:35], s65 offen lds
  s_waitcnt vmcnt(4)
  s_add_u32 m0, s7, 95232
  s_mov_b32 s65, 258048
  buffer_load_dwordx4 v254, s[32:35], s65 offen lds
  s_waitcnt vmcnt(4)
  s_add_u32 m0, s7, 99328
  s_mov_b32 s65, 286720
  buffer_load_dwordx4 v254, s[32:35], s65 offen lds
  s_waitcnt vmcnt(4)
  s_add_u32 m0, s7, 103424
  s_mov_b32 s65, 315392
  buffer_load_dwordx4 v254, s[32:35], s65 offen lds
  s_waitcnt vmcnt(4)
  s_add_u32 m0, s7, 107520
  s_mov_b32 s65, 344064
  buffer_load_dwordx4 v254, s[32:35], s65 offen lds
  s_waitcnt vmcnt(4)
  s_cmp_eq_u32 s52, 3
  s_cbranch_scc1 L_skip_32
  s_add_u32 m0, s7, 111616
  s_mov_b32 s65, 372736
  buffer_load_dwordx4 v254, s[32:35], s65 offen lds
L_skip_32:
  s_waitcnt vmcnt(4)
  s_lshr_b32 s64, s52, 1
  s_lshl_b32 s65, s64, 2
  v_mov_b32 v4, s65
  s_xor_b32 s64, s64, 1
  s_lshl_b32 s64, s64, 14
  s_add_u32 s64, s64, 114688
  s_add_u32 s65, s64, 3584
  v_lshl_add_u32 v3, v7, 4, s65
  s_and_b32 s65, s52, 1
  s_lshl_b32 s65, s65, 11
  s_add_u32 s64, s64, s65
  v_add_u32 v2, s64, v1
  s_mov_b32 s3, 1600000
L_cw_33:
  ds_read_b32 v13, v255 offset:8
  s_waitcnt lgkmcnt(0)
  v_cmp_gt_u32 vcc, 4, v13
  s_cbranch_vccz L_cw_done_34
  s_sleep 1
  s_sub_u32 s3, s3, 1
  s_cbranch_scc0 L_cw_33
L_cw_done_34:
  v_and_b32 v14, 15, v0
  v_lshlrev_b32 v14, 7, v14
  s_add_u32 s15, s5, 4096
  s_mov_b32 s16, 0
  s_mov_b32 s3, 200000
L_hf:
  buffer_load_dwordx2 v[10:11], v14, s[24:27], s4 offen sc1
  s_waitcnt vmcnt(0)
  v_cmp_ne_u64 vcc, s[54:55], v[10:11]
  s_cbranch_vccz L_hf_ok
  s_sleep 8
  ds_read_b32 v13, v4 offset:20
  s_waitcnt lgkmcnt(0)
  v_cmp_gt_u32 vcc, 4, v13
  s_cbranch_vccz L_hf_later
  s_sub_u32 s3, s3, 1
  s_cbranch_scc0 L_hf
  s_branch L_hf_later
L_hf_ok:
  s_mov_b32 s16, 1
  s_mov_b64 exec, 1
  ds_add_u32 v255, v5 offset:36
  s_mov_b64 exec, -1
  buffer_load_dwordx4 v[176:179], v1, s[24:27], s5 offen offset:0 sc1
  buffer_load_dwordx4 v[180:183], v1, s[24:27], s5 offen offset:1024 sc1
  buffer_load_dwordx4 v[184:187], v1, s[24:27], s5 offen offset:2048 sc1
  buffer_load_dwordx4 v[188:191], v1, s[24:27], s5 offen offset:3072 sc1
  buffer_load_dwordx4 v[192:195], v1, s[24:27], s15 offen offset:0 sc1
  buffer_load_dwordx4 v[196:199], v1, s[24:27], s15 offen offset:1024 sc1
  buffer_load_dwordx4 v[200:203], v1, s[24:27], s15 offen offset:2048 sc1
  buffer_load_dwordx4 v[204:207], v1, s[24:27], s15 offen offset:3072 sc1
L_hf_later:
  s_mov_b32 s3, 1600000
L_cw_35:
  ds_read_b32 v13, v4 offset:20
  s_waitcnt lgkmcnt(0)
  v_cmp_gt_u32 vcc, 4, v13
  s_cbranch_vccz L_cw_done_36
  s_sleep 1
  s_sub_u32 s3, s3, 1
  s_cbranch_scc0 L_cw_35
L_cw_done_36:
  ds_read_b128 v[56:59], v2 offset:0
  ds_read_b128 v[60:63], v2 offset:1024
  ds_read_b128 v[64:67], v2 offset:4096
  ds_read_b128 v[68:71], v2 offset:5120
  ds_read_b128 v[72:75], v2 offset:8192
  ds_read_b128 v[76:79], v2 offset:9216
  ds_read_b128 v[80:83], v2 offset:12288
  ds_read_b128 v[84:87], v2 offset:13312
  ds_read_b32 v136, v3 offset:0
  ds_read_b32 v137, v3 offset:4096
  ds_read_b32 v138, v3 offset:8192
  ds_read_b32 v139, v3 offset:12288
  s_waitcnt lgkmcnt(8)
  v_pk_add_f32 v[56:57], v[56:57], v[64:65]
  v_pk_add_f32 v[58:59], v[58:59], v[66:67]
  v_pk_add_f32 v[60:61], v[60:61], v[68:69]
  v_pk_add_f32 v[62:63], v[62:63], v[70:71]
  s_waitcnt lgkmcnt(4)
  v_pk_add_f32 v[72:73], v[72:73], v[80:81]
  v_pk_add_f32 v[74:75], v[74:75], v[82:83]
  v_pk_add_f32 v[76:77], v[76:77], v[84:85]
  v_pk_add_f32 v[78:79], v[78:79], v[86:87]
  v_pk_add_f32 v[56:57], v[56:57], v[72:73]
  v_pk_add_f32 v[58:59], v[58:59], v[74:75]
  v_pk_add_f32 v[60:61], v[60:61], v[76:77]
  v_pk_add_f32 v[62:63], v[62:63], v[78:79]
  s_waitcnt lgkmcnt(0)
  v_add_f32 v136, v136, v137
  v_add_f32 v138, v138, v139
  v_add_f32 v136, v136, v138
  s_mov_b64 exec, 1
  ds_add_u32 v255, v5 offset:32
  s_mov_b64 exec, -1
  s_cmp_lg_u32 s52, 2
  s_cbranch_scc1 L_no55
  s_mov_b32 m0, 114688
  s_mov_b32 s65, 379904
  buffer_load_dwordx4 v254, s[32:35], s65 offen lds
L_no55:
  v_rcp_f32 v11, v136
  v_med3_f32 v12, v136, v247, s8
  v_mul_f32 v10, v11, v9
  v_pk_mul_f32 v[56:57], v[56:57], v[10:11] op_sel_hi:[1,0]
  v_pk_mul_f32 v[58:59], v[58:59], v[10:11] op_sel_hi:[1,0]
  v_pk_mul_f32 v[60:61], v[60:61], v[10:11] op_sel_hi:[1,0]
  v_pk_mul_f32 v[62:63], v[62:63], v[10:11] op_sel_hi:[1,0]
  v_mul_f32 v11, v56, v57
  v_fma_f32 v11, v58, v59, v11
  v_fma_f32 v11, v60, v61, v11
  v_fma_f32 v11, v62, v63, v11
  v_fma_f32 v11, v11, 0, v136
  v_cmp_neq_f32 vcc, v11, v12
  s_cbranch_vccnz L_slowB0
L_finB0:
  v_cvt_pk_bf16_f32 v56, v56, v57
  v_cvt_pk_bf16_f32 v57, v58, v59
  v_cvt_pk_bf16_f32 v58, v60, v61
  v_cvt_pk_bf16_f32 v59, v62, v63
  v_and_b32 v58, v246, v58
  v_and_b32 v59, v246, v59
  buffer_store_dwordx4 v[56:59], v1, s[24:27], s61 offen offset:0 sc1
  s_add_u32 s61, s61, 65536
  s_waitcnt vmcnt(1)
  s_cmp_eq_u32 s16, 1
  s_cbranch_scc1 L_hf_done
  s_mov_b32 s3, 200000
L_poll_37:
  buffer_load_dwordx2 v[12:13], v14, s[24:27], s4 offen sc1
  s_waitcnt vmcnt(0)
  v_cmp_eq_u64 vcc, s[54:55], v[12:13]
  s_cmp_eq_u64 vcc, -1
  s_cbranch_scc1 L_poll_done_38
  s_sleep 4
  s_sub_u32 s3, s3, 1
  s_cbranch_scc0 L_poll_37
L_poll_done_38:
  s_mov_b64 exec, 1
  ds_add_u32 v255, v5 offset:36
  s_mov_b64 exec, -1
  buffer_load_dwordx4 v[176:179], v1, s[24:27], s5 offen offset:0 sc1
  buffer_load_dwordx4 v[180:183], v1, s[24:27], s5 offen offset:1024 sc1
  buffer_load_dwordx4 v[184:187], v1, s[24:27], s5 offen offset:2048 sc1
  buffer_load_dwordx4 v[188:191], v1, s[24:27], s5 offen offset:3072 sc1
  buffer_load_dwordx4 v[192:195], v1, s[24:27], s15 offen offset:0 sc1
  buffer_load_dwordx4 v[196:199], v1, s[24:27], s15 offen offset:1024 sc1
  buffer_load_dwordx4 v[200:203], v1, s[24:27], s15 offen offset:2048 sc1
  buffer_load_dwordx4 v[204:207], v1, s[24:27], s15 offen offset:3072 sc1
L_hf_done:
  s_cmp_ge_u32 s52, 2
  s_cbranch_scc1 L_h_t1
  s_mov_b32 s3, 1600000
L_cw_39:
  ds_read_b32 v13, v255 offset:28
  s_waitcnt lgkmcnt(0)
  v_cmp_gt_u32 vcc, 4, v13
  s_cbranch_vccz L_cw_done_40
  s_sleep 1
  s_sub_u32 s3, s3, 1
  s_cbranch_scc0 L_cw_39
L_cw_done_40:
  s_branch L_h_fin1
L_h_t1:
  s_barrier
L_h_fin1:
  ds_read_b128 v[56:59], v2 offset:16384
  ds_read_b128 v[60:63], v2 offset:17408
  ds_read_b128 v[64:67], v2 offset:20480
  ds_read_b128 v[68:71], v2 offset:21504
  ds_read_b128 v[72:75], v2 offset:24576
  ds_read_b128 v[76:79], v2 offset:25600
  ds_read_b128 v[80:83], v2 offset:28672
  ds_read_b128 v[84:87], v2 offset:29696
  ds_read_b32 v136, v3 offset:16384
  ds_read_b32 v137, v3 offset:20480
  ds_read_b32 v138, v3 offset:24576
  ds_read_b32 v139, v3 offset:28672
  s_waitcnt lgkmcnt(8)
  v_pk_add_f32 v[56:57], v[56:57], v[64:65]
  v_pk_add_f32 v[58:59], v[58:59], v[66:67]
  v_pk_add_f32 v[60:61], v[60:61], v[68:69]
  v_pk_add_f32 v[62:63], v[62:63], v[70:71]
  s_waitcnt lgkmcnt(4)
  v_pk_add_f32 v[72:73], v[72:73], v[80:81]
  v_pk_add_f32 v[74:75], v[74:75], v[82:83]
  v_pk_add_f32 v[76:77], v[76:77], v[84:85]
  v_pk_add_f32 v[78:79], v[78:79], v[86:87]
  v_pk_add_f32 v[56:57], v[56:57], v[72:73]
  v_pk_add_f32 v[58:59], v[58:59], v[74:75]
  v_pk_add_f32 v[60:61], v[60:61], v[76:77]
  v_pk_add_f32 v[62:63], v[62:63], v[78:79]
  s_waitcnt lgkmcnt(0)
  v_add_f32 v136, v136, v137
  v_add_f32 v138, v138, v139
  v_add_f32 v136, v136, v138
  v_rcp_f32 v11, v136
  v_med3_f32 v12, v136, v247, s8
  v_mul_f32 v10, v11, v248
  v_pk_mul_f32 v[56:57], v[56:57], v[10:11] op_sel_hi:[1,0]
  v_pk_mul_f32 v[58:59], v[58:59], v[10:11] op_sel_hi:[1,0]
  v_pk_mul_f32 v[60:61], v[60:61], v[10:11] op_sel_hi:[1,0]
  v_pk_mul_f32 v[62:63], v[62:63], v[10:11] op_sel_hi:[1,0]
  v_mul_f32 v11, v56, v57
  v_fma_f32 v11, v58, v59, v11
  v_fma_f32 v11, v60, v61, v11
  v_fma_f32 v11, v62, v63, v11
  v_fma_f32 v11, v11, 0, v136
  v_cmp_neq_f32 vcc, v11, v12
  s_cbranch_vccnz L_slowB1
L_finB1:
  v_cvt_pk_bf16_f32 v56, v56, v57
  v_cvt_pk_bf16_f32 v57, v58, v59
  v_cvt_pk_bf16_f32 v58, v60, v61
  v_cvt_pk_bf16_f32 v59, v62, v63
  v_and_b32 v58, v246, v58
  v_and_b32 v59, v246, v59
  buffer_store_dwordx4 v[56:59], v1, s[24:27], s61 offen offset:0 sc1
  s_cmp_ge_u32 s52, 2
  s_cbranch_scc1 L_tail
  s_barrier
  s_branch L_tail
L_main:
  s_waitcnt lgkmcnt(0)
  s_waitcnt vmcnt(18)
  v_mfma_f32_32x32x16_bf16 v[112:127], v[144:147], v[16:19], 0
  v_mfma_f32_32x32x16_bf16 v[112:127], v[148:151], v[20:23], v[112:127]
  s_nop 11
  v_exp_f32 v112, v112
  v_exp_f32 v113, v113
  v_exp_f32 v114, v114
  v_exp_f32 v115, v115
  v_exp_f32 v116, v116
  s_waitcnt vmcnt(16)
  v_mfma_f32_32x32x16_bf16 v[128:143], v[144:147], v[24:27], 0
  v_exp_f32 v117, v117
  v_exp_f32 v118, v118
  v_exp_f32 v119, v119
  v_mfma_f32_32x32x16_bf16 v[128:143], v[148:151], v[28:31], v[128:143]
  v_exp_f32 v120, v120
  v_exp_f32 v121, v121
  v_exp_f32 v122, v122
  v_exp_f32 v123, v123
  v_smfmac_f32_32x32x32_bf16 v[48:63], v[152:155], v[112:119], v6
  v_exp_f32 v124, v124
  v_exp_f32 v125, v125
  v_exp_f32 v126, v126
  v_exp_f32 v127, v127
  v_exp_f32 v128, v128
  v_exp_f32 v129, v129
  v_smfmac_f32_32x32x32_bf16 v[48:63], v[156:159], v[120:127], v6
  v_exp_f32 v130, v130
  v_exp_f32 v131, v131
  v_exp_f32 v132, v132
  v_mfma_f32_32x32x16_bf16 v[112:127], v[144:147], v[32:35], 0
  v_exp_f32 v133, v133
  v_exp_f32 v134, v134
  v_exp_f32 v135, v135
  v_mfma_f32_32x32x16_bf16 v[112:127], v[148:151], v[36:39], v[112:127]
  v_exp_f32 v136, v136
  v_exp_f32 v137, v137
  v_exp_f32 v138, v138
  v_exp_f32 v139, v139
  v_smfmac_f32_32x32x32_bf16 v[64:79], v[152:155], v[128:135], v6
  v_exp_f32 v140, v140
  v_exp_f32 v141, v141
  v_exp_f32 v142, v142
  v_exp_f32 v143, v143
  v_exp_f32 v112, v112
  v_exp_f32 v113, v113
  v_smfmac_f32_32x32x32_bf16 v[64:79], v[156:159], v[136:143], v6
  v_exp_f32 v114, v114
  v_exp_f32 v115, v115
  v_exp_f32 v116, v116
  v_mfma_f32_32x32x16_bf16 v[128:143], v[144:147], v[40:43], 0
  v_exp_f32 v117, v117
  v_exp_f32 v118, v118
  v_exp_f32 v119, v119
  v_mfma_f32_32x32x16_bf16 v[128:143], v[148:151], v[44:47], v[128:143]
  v_exp_f32 v120, v120
  v_exp_f32 v121, v121
  v_exp_f32 v122, v122
  v_exp_f32 v123, v123
  v_smfmac_f32_32x32x32_bf16 v[80:95], v[152:155], v[112:119], v6
  v_exp_f32 v124, v124
  v_exp_f32 v125, v125
  v_exp_f32 v126, v126
  v_exp_f32 v127, v127
  v_exp_f32 v128, v128
  v_exp_f32 v129, v129
  v_smfmac_f32_32x32x32_bf16 v[80:95], v[156:159], v[120:127], v6
  v_exp_f32 v130, v130
  v_exp_f32 v131, v131
  v_exp_f32 v132, v132
  s_waitcnt vmcnt(12)
  v_mfma_f32_32x32x16_bf16 v[112:127], v[160:163], v[16:19], 0
  v_exp_f32 v133, v133
  v_exp_f32 v134, v134
  v_exp_f32 v135, v135
  v_mfma_f32_32x32x16_bf16 v[112:127], v[164:167], v[20:23], v[112:127]
  v_exp_f32 v136, v136
  v_exp_f32 v137, v137
  v_exp_f32 v138, v138
  v_exp_f32 v139, v139
  v_smfmac_f32_32x32x32_bf16 v[96:111], v[152:155], v[128:135], v6
  v_exp_f32 v140, v140
  v_exp_f32 v141, v141
  v_exp_f32 v142, v142
  v_exp_f32 v143, v143
  v_exp_f32 v112, v112
  v_exp_f32 v113, v113
  v_smfmac_f32_32x32x32_bf16 v[96:111], v[156:159], v[136:143], v6
  v_exp_f32 v114, v114
  v_exp_f32 v115, v115
  v_exp_f32 v116, v116
  v_mfma_f32_32x32x16_bf16 v[128:143], v[160:163], v[24:27], 0
  s_mov_b32 s57, 20480
  buffer_load_dwordx4 v[192:195], v2, s[24:27], s57 offen offset:0 sc1
  v_exp_f32 v117, v117
  v_exp_f32 v118, v118
  v_exp_f32 v119, v119
  v_mfma_f32_32x32x16_bf16 v[128:143], v[164:167], v[28:31], v[128:143]
  v_exp_f32 v120, v120
  v_exp_f32 v121, v121
  v_exp_f32 v122, v122
  v_exp_f32 v123, v123
  v_smfmac_f32_32x32x32_bf16 v[48:63], v[168:171], v[112:119], v6
  v_exp_f32 v124, v124
  v_exp_f32 v125, v125
  v_exp_f32 v126, v126
  v_exp_f32 v127, v127
  v_exp_f32 v128, v128
  v_exp_f32 v129, v129
  v_smfmac_f32_32x32x32_bf16 v[48:63], v[172:175], v[120:127], v6
  v_exp_f32 v130, v130
  v_exp_f32 v131, v131
  v_exp_f32 v132, v132
  v_mfma_f32_32x32x16_bf16 v[112:127], v[160:163], v[32:35], 0
  buffer_load_dwordx4 v[196:199], v2, s[24:27], s57 offen offset:1024 sc1
  v_exp_f32 v133, v133
  v_exp_f32 v134, v134
  v_exp_f32 v135, v135
  v_mfma_f32_32x32x16_bf16 v[112:127], v[164:167], v[36:39], v[112:127]
  v_exp_f32 v136, v136
  v_exp_f32 v137, v137
  v_exp_f32 v138, v138
  v_exp_f32 v139, v139
  v_smfmac_f32_32x32x32_bf16 v[64:79], v[168:171], v[128:135], v6
  v_exp_f32 v140, v140
  v_exp_f32 v141, v141
  v_exp_f32 v142, v142
  v_exp_f32 v143, v143
  v_exp_f32 v112, v112
  v_exp_f32 v113, v113
  v_smfmac_f32_32x32x32_bf16 v[64:79], v[172:175], v[136:143], v6
  v_exp_f32 v114, v114
  v_exp_f32 v115, v115
  v_exp_f32 v116, v116
  v_mfma_f32_32x32x16_bf16 v[128:143], v[160:163], v[40:43], 0
  buffer_load_dwordx4 v[200:203], v2, s[24:27], s57 offen offset:2048 sc1
  v_exp_f32 v117, v117
  v_exp_f32 v118, v118
  v_exp_f32 v119, v119
  v_mfma_f32_32x32x16_bf16 v[128:143], v[164:167], v[44:47], v[128:143]
  v_exp_f32 v120, v120
  v_exp_f32 v121, v121
  v_exp_f32 v122, v122
  v_exp_f32 v123, v123
  v_smfmac_f32_32x32x32_bf16 v[80:95], v[168:171], v[112:119], v6
  v_exp_f32 v124, v124
  v_exp_f32 v125, v125
  v_exp_f32 v126, v126
  v_exp_f32 v127, v127
  v_exp_f32 v128, v128
  v_exp_f32 v129, v129
  v_smfmac_f32_32x32x32_bf16 v[80:95], v[172:175], v[120:127], v6
  v_exp_f32 v130, v130
  v_exp_f32 v131, v131
  v_exp_f32 v132, v132
  s_waitcnt vmcnt(11)
  v_mfma_f32_32x32x16_bf16 v[112:127], v[208:211], v[16:19], 0
  buffer_load_dwordx4 v[204:207], v2, s[24:27], s57 offen offset:3072 sc1
  v_exp_f32 v133, v133
  v_exp_f32 v134, v134
  v_exp_f32 v135, v135
  v_mfma_f32_32x32x16_bf16 v[112:127], v[212:215], v[20:23], v[112:127]
  v_exp_f32 v136, v136
  v_exp_f32 v137, v137
  v_exp_f32 v138, v138
  v_exp_f32 v139, v139
  v_smfmac_f32_32x32x32_bf16 v[96:111], v[168:171], v[128:135], v6
  v_exp_f32 v140, v140
  v_exp_f32 v141, v141
  v_exp_f32 v142, v142
  v_exp_f32 v143, v143
  v_exp_f32 v112, v112
  v_exp_f32 v113, v113
  v_smfmac_f32_32x32x32_bf16 v[96:111], v[172:175], v[136:143], v6
  v_exp_f32 v114, v114
  v_exp_f32 v115, v115
  v_exp_f32 v116, v116
  v_mfma_f32_32x32x16_bf16 v[128:143], v[208:211], v[24:27], 0
  s_mov_b32 s57, 24576
  buffer_load_dwordx4 v[144:147], v2, s[24:27], s57 offen offset:0 sc1
  v_exp_f32 v117, v117
  v_exp_f32 v118, v118
  v_exp_f32 v119, v119
  v_mfma_f32_32x32x16_bf16 v[128:143], v[212:215], v[28:31], v[128:143]
  v_exp_f32 v120, v120
  v_exp_f32 v121, v121
  v_exp_f32 v122, v122
  v_exp_f32 v123, v123
  v_smfmac_f32_32x32x32_bf16 v[48:63], v[216:219], v[112:119], v6
  v_exp_f32 v124, v124
  v_exp_f32 v125, v125
  v_exp_f32 v126, v126
  v_exp_f32 v127, v127
  v_exp_f32 v128, v128
  v_exp_f32 v129, v129
  v_smfmac_f32_32x32x32_bf16 v[48:63], v[220:223], v[120:127], v6
  v_exp_f32 v130, v130
  v_exp_f32 v131, v131
  v_exp_f32 v132, v132
  v_mfma_f32_32x32x16_bf16 v[112:127], v[208:211], v[32:35], 0
  buffer_load_dwordx4 v[148:151], v2, s[24:27], s57 offen offset:1024 sc1
  v_exp_f32 v133, v133
  v_exp_f32 v134, v134
  v_exp_f32 v135, v135
  v_mfma_f32_32x32x16_bf16 v[112:127], v[212:215], v[36:39], v[112:127]
  v_exp_f32 v136, v136
  v_exp_f32 v137, v137
  v_exp_f32 v138, v138
  v_exp_f32 v139, v139
  v_smfmac_f32_32x32x32_bf16 v[64:79], v[216:219], v[128:135], v6
  v_exp_f32 v140, v140
  v_exp_f32 v141, v141
  v_exp_f32 v142, v142
  v_exp_f32 v143, v143
  v_exp_f32 v112, v112
  v_exp_f32 v113, v113
  v_smfmac_f32_32x32x32_bf16 v[64:79], v[220:223], v[136:143], v6
  v_exp_f32 v114, v114
  v_exp_f32 v115, v115
  v_exp_f32 v116, v116
  v_mfma_f32_32x32x16_bf16 v[128:143], v[208:211], v[40:43], 0
  buffer_load_dwordx4 v[152:155], v2, s[24:27], s57 offen offset:2048 sc1
  v_exp_f32 v117, v117
  v_exp_f32 v118, v118
  v_exp_f32 v119, v119
  v_mfma_f32_32x32x16_bf16 v[128:143], v[212:215], v[44:47], v[128:143]
  v_exp_f32 v120, v120
  v_exp_f32 v121, v121
  v_exp_f32 v122, v122
  v_exp_f32 v123, v123
  v_smfmac_f32_32x32x32_bf16 v[80:95], v[216:219], v[112:119], v6
  v_exp_f32 v124, v124
  v_exp_f32 v125, v125
  v_exp_f32 v126, v126
  v_exp_f32 v127, v127
  v_exp_f32 v128, v128
  v_exp_f32 v129, v129
  v_smfmac_f32_32x32x32_bf16 v[80:95], v[220:223], v[120:127], v6
  v_exp_f32 v130, v130
  v_exp_f32 v131, v131
  v_exp_f32 v132, v132
  s_waitcnt vmcnt(11)
  v_mfma_f32_32x32x16_bf16 v[112:127], v[224:227], v[16:19], 0
  buffer_load_dwordx4 v[156:159], v2, s[24:27], s57 offen offset:3072 sc1
  v_exp_f32 v133, v133
  v_exp_f32 v134, v134
  v_exp_f32 v135, v135
  v_mfma_f32_32x32x16_bf16 v[112:127], v[228:231], v[20:23], v[112:127]
  v_exp_f32 v136, v136
  v_exp_f32 v137, v137
  v_exp_f32 v138, v138
  v_exp_f32 v139, v139
  v_smfmac_f32_32x32x32_bf16 v[96:111], v[216:219], v[128:135], v6
  v_exp_f32 v140, v140
  v_exp_f32 v141, v141
  v_exp_f32 v142, v142
  v_exp_f32 v143, v143
  v_exp_f32 v112, v112
  v_exp_f32 v113, v113
  v_smfmac_f32_32x32x32_bf16 v[96:111], v[220:223], v[136:143], v6
  v_exp_f32 v114, v114
  v_exp_f32 v115, v115
  v_exp_f32 v116, v116
  v_mfma_f32_32x32x16_bf16 v[128:143], v[224:227], v[24:27], 0
  s_mov_b32 s57, 28672
  buffer_load_dwordx4 v[160:163], v2, s[24:27], s57 offen offset:0 sc1
  v_exp_f32 v117, v117
  v_exp_f32 v118, v118
  v_exp_f32 v119, v119
  v_mfma_f32_32x32x16_bf16 v[128:143], v[228:231], v[28:31], v[128:143]
  v_exp_f32 v120, v120
  v_exp_f32 v121, v121
  v_exp_f32 v122, v122
  v_exp_f32 v123, v123
  v_smfmac_f32_32x32x32_bf16 v[48:63], v[232:235], v[112:119], v6
  v_exp_f32 v124, v124
  v_exp_f32 v125, v125
  v_exp_f32 v126, v126
  v_exp_f32 v127, v127
  v_exp_f32 v128, v128
  v_exp_f32 v129, v129
  v_smfmac_f32_32x32x32_bf16 v[48:63], v[236:239], v[120:127], v6
  v_exp_f32 v130, v130
  v_exp_f32 v131, v131
  v_exp_f32 v132, v132
  v_mfma_f32_32x32x16_bf16 v[112:127], v[224:227], v[32:35], 0
  buffer_load_dwordx4 v[164:167], v2, s[24:27], s57 offen offset:1024 sc1
  v_exp_f32 v133, v133
  v_exp_f32 v134, v134
  v_exp_f32 v135, v135
  v_mfma_f32_32x32x16_bf16 v[112:127], v[228:231], v[36:39], v[112:127]
  v_exp_f32 v136, v136
  v_exp_f32 v137, v137
  v_exp_f32 v138, v138
  v_exp_f32 v139, v139
  v_smfmac_f32_32x32x32_bf16 v[64:79], v[232:235], v[128:135], v6
  v_exp_f32 v140, v140
  v_exp_f32 v141, v141
  v_exp_f32 v142, v142
  v_exp_f32 v143, v143
  v_exp_f32 v112, v112
  v_exp_f32 v113, v113
  v_smfmac_f32_32x32x32_bf16 v[64:79], v[236:239], v[136:143], v6
  v_exp_f32 v114, v114
  v_exp_f32 v115, v115
  v_exp_f32 v116, v116
  v_mfma_f32_32x32x16_bf16 v[128:143], v[224:227], v[40:43], 0
  buffer_load_dwordx4 v[168:171], v2, s[24:27], s57 offen offset:2048 sc1
  v_exp_f32 v117, v117
  v_exp_f32 v118, v118
  v_exp_f32 v119, v119
  v_mfma_f32_32x32x16_bf16 v[128:143], v[228:231], v[44:47], v[128:143]
  v_exp_f32 v120, v120
  v_exp_f32 v121, v121
  v_exp_f32 v122, v122
  v_exp_f32 v123, v123
  v_smfmac_f32_32x32x32_bf16 v[80:95], v[232:235], v[112:119], v6
  v_exp_f32 v124, v124
  v_exp_f32 v125, v125
  v_exp_f32 v126, v126
  v_exp_f32 v127, v127
  v_exp_f32 v128, v128
  v_exp_f32 v129, v129
  v_smfmac_f32_32x32x32_bf16 v[80:95], v[236:239], v[120:127], v6
  v_exp_f32 v130, v130
  v_exp_f32 v131, v131
  v_exp_f32 v132, v132
  s_waitcnt vmcnt(11)
  v_mfma_f32_32x32x16_bf16 v[112:127], v[176:179], v[16:19], 0
  buffer_load_dwordx4 v[172:175], v2, s[24:27], s57 offen offset:3072 sc1
  v_exp_f32 v133, v133
  v_exp_f32 v134, v134
  v_exp_f32 v135, v135
  v_mfma_f32_32x32x16_bf16 v[112:127], v[180:183], v[20:23], v[112:127]
  v_exp_f32 v136, v136
  v_exp_f32 v137, v137
  v_exp_f32 v138, v138
  v_exp_f32 v139, v139
  v_smfmac_f32_32x32x32_bf16 v[96:111], v[232:235], v[128:135], v6
  v_exp_f32 v140, v140
  v_exp_f32 v141, v141
  v_exp_f32 v142, v142
  v_exp_f32 v143, v143
  v_exp_f32 v112, v112
  v_exp_f32 v113, v113
  v_smfmac_f32_32x32x32_bf16 v[96:111], v[236:239], v[136:143], v6
  v_exp_f32 v114, v114
  v_exp_f32 v115, v115
  v_exp_f32 v116, v116
  v_mfma_f32_32x32x16_bf16 v[128:143], v[176:179], v[24:27], 0
  s_mov_b32 s57, 32768
  buffer_load_dwordx4 v[208:211], v2, s[24:27], s57 offen offset:0 sc1
  v_exp_f32 v117, v117
  v_exp_f32 v118, v118
  v_exp_f32 v119, v119
  v_mfma_f32_32x32x16_bf16 v[128:143], v[180:183], v[28:31], v[128:143]
  v_exp_f32 v120, v120
  v_exp_f32 v121, v121
  v_exp_f32 v122, v122
  v_exp_f32 v123, v123
  v_smfmac_f32_32x32x32_bf16 v[48:63], v[184:187], v[112:119], v6
  v_exp_f32 v124, v124
  v_exp_f32 v125, v125
  v_exp_f32 v126, v126
  v_exp_f32 v127, v127
  v_exp_f32 v128, v128
  v_exp_f32 v129, v129
  v_smfmac_f32_32x32x32_bf16 v[48:63], v[188:191], v[120:127], v6
  v_exp_f32 v130, v130
  v_exp_f32 v131, v131
  v_exp_f32 v132, v132
  v_mfma_f32_32x32x16_bf16 v[112:127], v[176:179], v[32:35], 0
  buffer_load_dwordx4 v[212:215], v2, s[24:27], s57 offen offset:1024 sc1
  v_exp_f32 v133, v133
  v_exp_f32 v134, v134
  v_exp_f32 v135, v135
  v_mfma_f32_32x32x16_bf16 v[112:127], v[180:183], v[36:39], v[112:127]
  v_exp_f32 v136, v136
  v_exp_f32 v137, v137
  v_exp_f32 v138, v138
  v_exp_f32 v139, v139
  v_smfmac_f32_32x32x32_bf16 v[64:79], v[184:187], v[128:135], v6
  v_exp_f32 v140, v140
  v_exp_f32 v141, v141
  v_exp_f32 v142, v142
  v_exp_f32 v143, v143
  v_exp_f32 v112, v112
  v_exp_f32 v113, v113
  v_smfmac_f32_32x32x32_bf16 v[64:79], v[188:191], v[136:143], v6
  v_exp_f32 v114, v114
  v_exp_f32 v115, v115
  v_exp_f32 v116, v116
  v_mfma_f32_32x32x16_bf16 v[128:143], v[176:179], v[40:43], 0
  buffer_load_dwordx4 v[216:219], v2, s[24:27], s57 offen offset:2048 sc1
  v_exp_f32 v117, v117
  v_exp_f32 v118, v118
  v_exp_f32 v119, v119
  v_mfma_f32_32x32x16_bf16 v[128:143], v[180:183], v[44:47], v[128:143]
  v_exp_f32 v120, v120
  v_exp_f32 v121, v121
  v_exp_f32 v122, v122
  v_exp_f32 v123, v123
  v_smfmac_f32_32x32x32_bf16 v[80:95], v[184:187], v[112:119], v6
  v_exp_f32 v124, v124
  v_exp_f32 v125, v125
  v_exp_f32 v126, v126
  v_exp_f32 v127, v127
  v_exp_f32 v128, v128
  v_exp_f32 v129, v129
  v_smfmac_f32_32x32x32_bf16 v[80:95], v[188:191], v[120:127], v6
  v_exp_f32 v130, v130
  v_exp_f32 v131, v131
  v_exp_f32 v132, v132
  s_waitcnt vmcnt(11)
  v_mfma_f32_32x32x16_bf16 v[112:127], v[192:195], v[16:19], 0
  buffer_load_dwordx4 v[220:223], v2, s[24:27], s57 offen offset:3072 sc1
  v_exp_f32 v133, v133
  v_exp_f32 v134, v134
  v_exp_f32 v135, v135
  v_mfma_f32_32x32x16_bf16 v[112:127], v[196:199], v[20:23], v[112:127]
  v_exp_f32 v136, v136
  v_exp_f32 v137, v137
  v_exp_f32 v138, v138
  v_exp_f32 v139, v139
  v_smfmac_f32_32x32x32_bf16 v[96:111], v[184:187], v[128:135], v6
  v_exp_f32 v140, v140
  v_exp_f32 v141, v141
  v_exp_f32 v142, v142
  v_exp_f32 v143, v143
  v_exp_f32 v112, v112
  v_exp_f32 v113, v113
  v_smfmac_f32_32x32x32_bf16 v[96:111], v[188:191], v[136:143], v6
  v_exp_f32 v114, v114
  v_exp_f32 v115, v115
  v_exp_f32 v116, v116
  v_mfma_f32_32x32x16_bf16 v[128:143], v[192:195], v[24:27], 0
  s_mov_b32 s57, 36864
  buffer_load_dwordx4 v[224:227], v2, s[24:27], s57 offen offset:0 sc1
  v_exp_f32 v117, v117
  v_exp_f32 v118, v118
  v_exp_f32 v119, v119
  v_mfma_f32_32x32x16_bf16 v[128:143], v[196:199], v[28:31], v[128:143]
  v_exp_f32 v120, v120
  v_exp_f32 v121, v121
  v_exp_f32 v122, v122
  v_exp_f32 v123, v123
  v_smfmac_f32_32x32x32_bf16 v[48:63], v[200:203], v[112:119], v6
  v_exp_f32 v124, v124
  v_exp_f32 v125, v125
  v_exp_f32 v126, v126
  v_exp_f32 v127, v127
  v_exp_f32 v128, v128
  v_exp_f32 v129, v129
  v_smfmac_f32_32x32x32_bf16 v[48:63], v[204:207], v[120:127], v6
  v_exp_f32 v130, v130
  v_exp_f32 v131, v131
  v_exp_f32 v132, v132
  v_mfma_f32_32x32x16_bf16 v[112:127], v[192:195], v[32:35], 0
  buffer_load_dwordx4 v[228:231], v2, s[24:27], s57 offen offset:1024 sc1
  v_exp_f32 v133, v133
  v_exp_f32 v134, v134
  v_exp_f32 v135, v135
  v_mfma_f32_32x32x16_bf16 v[112:127], v[196:199], v[36:39], v[112:127]
  v_exp_f32 v136, v136
  v_exp_f32 v137, v137
  v_exp_f32 v138, v138
  v_exp_f32 v139, v139
  v_smfmac_f32_32x32x32_bf16 v[64:79], v[200:203], v[128:135], v6
  v_exp_f32 v140, v140
  v_exp_f32 v141, v141
  v_exp_f32 v142, v142
  v_exp_f32 v143, v143
  v_exp_f32 v112, v112
  v_exp_f32 v113, v113
  v_smfmac_f32_32x32x32_bf16 v[64:79], v[204:207], v[136:143], v6
  v_exp_f32 v114, v114
  v_exp_f32 v115, v115
  v_exp_f32 v116, v116
  v_mfma_f32_32x32x16_bf16 v[128:143], v[192:195], v[40:43], 0
  buffer_load_dwordx4 v[232:235], v2, s[24:27], s57 offen offset:2048 sc1
  v_exp_f32 v117, v117
  v_exp_f32 v118, v118
  v_exp_f32 v119, v119
  v_mfma_f32_32x32x16_bf16 v[128:143], v[196:199], v[44:47], v[128:143]
  v_exp_f32 v120, v120
  v_exp_f32 v121, v121
  v_exp_f32 v122, v122
  v_exp_f32 v123, v123
  v_smfmac_f32_32x32x32_bf16 v[80:95], v[200:203], v[112:119], v6
  v_exp_f32 v124, v124
  v_exp_f32 v125, v125
  v_exp_f32 v126, v126
  v_exp_f32 v127, v127
  v_exp_f32 v128, v128
  v_exp_f32 v129, v129
  v_smfmac_f32_32x32x32_bf16 v[80:95], v[204:207], v[120:127], v6
  v_exp_f32 v130, v130
  v_exp_f32 v131, v131
  v_exp_f32 v132, v132
  s_waitcnt vmcnt(11)
  v_mfma_f32_32x32x16_bf16 v[112:127], v[144:147], v[16:19], 0
  buffer_load_dwordx4 v[236:239], v2, s[24:27], s57 offen offset:3072 sc1
  v_exp_f32 v133, v133
  v_exp_f32 v134, v134
  v_exp_f32 v135, v135
  v_mfma_f32_32x32x16_bf16 v[112:127], v[148:151], v[20:23], v[112:127]
  v_exp_f32 v136, v136
  v_exp_f32 v137, v137
  v_exp_f32 v138, v138
  v_exp_f32 v139, v139
  v_smfmac_f32_32x32x32_bf16 v[96:111], v[200:203], v[128:135], v6
  v_exp_f32 v140, v140
  v_exp_f32 v141, v141
  v_exp_f32 v142, v142
  v_exp_f32 v143, v143
  v_exp_f32 v112, v112
  v_exp_f32 v113, v113
  v_smfmac_f32_32x32x32_bf16 v[96:111], v[204:207], v[136:143], v6
  v_exp_f32 v114, v114
  v_exp_f32 v115, v115
  v_exp_f32 v116, v116
  v_mfma_f32_32x32x16_bf16 v[128:143], v[144:147], v[24:27], 0
  s_mov_b32 s57, 40960
  buffer_load_dwordx4 v[176:179], v2, s[24:27], s57 offen offset:0 sc1
  v_exp_f32 v117, v117
  v_exp_f32 v118, v118
  v_exp_f32 v119, v119
  v_mfma_f32_32x32x16_bf16 v[128:143], v[148:151], v[28:31], v[128:143]
  v_exp_f32 v120, v120
  v_exp_f32 v121, v121
  v_exp_f32 v122, v122
  v_exp_f32 v123, v123
  v_smfmac_f32_32x32x32_bf16 v[48:63], v[152:155], v[112:119], v6
  v_exp_f32 v124, v124
  v_exp_f32 v125, v125
  v_exp_f32 v126, v126
  v_exp_f32 v127, v127
  v_exp_f32 v128, v128
  v_exp_f32 v129, v129
  v_smfmac_f32_32x32x32_bf16 v[48:63], v[156:159], v[120:127], v6
  v_exp_f32 v130, v130
  v_exp_f32 v131, v131
  v_exp_f32 v132, v132
  v_mfma_f32_32x32x16_bf16 v[112:127], v[144:147], v[32:35], 0
  buffer_load_dwordx4 v[180:183], v2, s[24:27], s57 offen offset:1024 sc1
  v_exp_f32 v133, v133
  v_exp_f32 v134, v134
  v_exp_f32 v135, v135
  v_mfma_f32_32x32x16_bf16 v[112:127], v[148:151], v[36:39], v[112:127]
  v_exp_f32 v136, v136
  v_exp_f32 v137, v137
  v_exp_f32 v138, v138
  v_exp_f32 v139, v139
  v_smfmac_f32_32x32x32_bf16 v[64:79], v[152:155], v[128:135], v6
  v_exp_f32 v140, v140
  v_exp_f32 v141, v141
  v_exp_f32 v142, v142
  v_exp_f32 v143, v143
  v_exp_f32 v112, v112
  v_exp_f32 v113, v113
  v_smfmac_f32_32x32x32_bf16 v[64:79], v[156:159], v[136:143], v6
  v_exp_f32 v114, v114
  v_exp_f32 v115, v115
  v_exp_f32 v116, v116
  v_mfma_f32_32x32x16_bf16 v[128:143], v[144:147], v[40:43], 0
  buffer_load_dwordx4 v[184:187], v2, s[24:27], s57 offen offset:2048 sc1
  v_exp_f32 v117, v117
  v_exp_f32 v118, v118
  v_exp_f32 v119, v119
  v_mfma_f32_32x32x16_bf16 v[128:143], v[148:151], v[44:47], v[128:143]
  v_exp_f32 v120, v120
  v_exp_f32 v121, v121
  v_exp_f32 v122, v122
  v_exp_f32 v123, v123
  v_smfmac_f32_32x32x32_bf16 v[80:95], v[152:155], v[112:119], v6
  v_exp_f32 v124, v124
  v_exp_f32 v125, v125
  v_exp_f32 v126, v126
  v_exp_f32 v127, v127
  v_exp_f32 v128, v128
  v_exp_f32 v129, v129
  v_smfmac_f32_32x32x32_bf16 v[80:95], v[156:159], v[120:127], v6
  v_exp_f32 v130, v130
  v_exp_f32 v131, v131
  v_exp_f32 v132, v132
  s_waitcnt vmcnt(11)
  v_mfma_f32_32x32x16_bf16 v[112:127], v[160:163], v[16:19], 0
  buffer_load_dwordx4 v[188:191], v2, s[24:27], s57 offen offset:3072 sc1
  v_exp_f32 v133, v133
  v_exp_f32 v134, v134
  v_exp_f32 v135, v135
  v_mfma_f32_32x32x16_bf16 v[112:127], v[164:167], v[20:23], v[112:127]
  v_exp_f32 v136, v136
  v_exp_f32 v137, v137
  v_exp_f32 v138, v138
  v_exp_f32 v139, v139
  v_smfmac_f32_32x32x32_bf16 v[96:111], v[152:155], v[128:135], v6
  v_exp_f32 v140, v140
  v_exp_f32 v141, v141
  v_exp_f32 v142, v142
  v_exp_f32 v143, v143
  v_exp_f32 v112, v112
  v_exp_f32 v113, v113
  v_smfmac_f32_32x32x32_bf16 v[96:111], v[156:159], v[136:143], v6
  v_exp_f32 v114, v114
  v_exp_f32 v115, v115
  v_exp_f32 v116, v116
  v_mfma_f32_32x32x16_bf16 v[128:143], v[160:163], v[24:27], 0
  s_mov_b32 s57, 45056
  buffer_load_dwordx4 v[192:195], v2, s[24:27], s57 offen offset:0 sc1
  v_exp_f32 v117, v117
  v_exp_f32 v118, v118
  v_exp_f32 v119, v119
  v_mfma_f32_32x32x16_bf16 v[128:143], v[164:167], v[28:31], v[128:143]
  v_exp_f32 v120, v120
  v_exp_f32 v121, v121
  v_exp_f32 v122, v122
  v_exp_f32 v123, v123
  v_smfmac_f32_32x32x32_bf16 v[48:63], v[168:171], v[112:119], v6
  v_exp_f32 v124, v124
  v_exp_f32 v125, v125
  v_exp_f32 v126, v126
  v_exp_f32 v127, v127
  v_exp_f32 v128, v128
  v_exp_f32 v129, v129
  v_smfmac_f32_32x32x32_bf16 v[48:63], v[172:175], v[120:127], v6
  v_exp_f32 v130, v130
  v_exp_f32 v131, v131
  v_exp_f32 v132, v132
  v_mfma_f32_32x32x16_bf16 v[112:127], v[160:163], v[32:35], 0
  buffer_load_dwordx4 v[196:199], v2, s[24:27], s57 offen offset:1024 sc1
  v_exp_f32 v133, v133
  v_exp_f32 v134, v134
  v_exp_f32 v135, v135
  v_mfma_f32_32x32x16_bf16 v[112:127], v[164:167], v[36:39], v[112:127]
  v_exp_f32 v136, v136
  v_exp_f32 v137, v137
  v_exp_f32 v138, v138
  v_exp_f32 v139, v139
  v_smfmac_f32_32x32x32_bf16 v[64:79], v[168:171], v[128:135], v6
  v_exp_f32 v140, v140
  v_exp_f32 v141, v141
  v_exp_f32 v142, v142
  v_exp_f32 v143, v143
  v_exp_f32 v112, v112
  v_exp_f32 v113, v113
  v_smfmac_f32_32x32x32_bf16 v[64:79], v[172:175], v[136:143], v6
  v_exp_f32 v114, v114
  v_exp_f32 v115, v115
  v_exp_f32 v116, v116
  v_mfma_f32_32x32x16_bf16 v[128:143], v[160:163], v[40:43], 0
  buffer_load_dwordx4 v[200:203], v2, s[24:27], s57 offen offset:2048 sc1
  v_exp_f32 v117, v117
  v_exp_f32 v118, v118
  v_exp_f32 v119, v119
  v_mfma_f32_32x32x16_bf16 v[128:143], v[164:167], v[44:47], v[128:143]
  v_exp_f32 v120, v120
  v_exp_f32 v121, v121
  v_exp_f32 v122, v122
  v_exp_f32 v123, v123
  v_smfmac_f32_32x32x32_bf16 v[80:95], v[168:171], v[112:119], v6
  v_exp_f32 v124, v124
  v_exp_f32 v125, v125
  v_exp_f32 v126, v126
  v_exp_f32 v127, v127
  v_exp_f32 v128, v128
  v_exp_f32 v129, v129
  v_smfmac_f32_32x32x32_bf16 v[80:95], v[172:175], v[120:127], v6
  v_exp_f32 v130, v130
  v_exp_f32 v131, v131
  v_exp_f32 v132, v132
  s_waitcnt vmcnt(11)
  v_mfma_f32_32x32x16_bf16 v[112:127], v[208:211], v[16:19], 0
  buffer_load_dwordx4 v[204:207], v2, s[24:27], s57 offen offset:3072 sc1
  v_exp_f32 v133, v133
  v_exp_f32 v134, v134
  v_exp_f32 v135, v135
  v_mfma_f32_32x32x16_bf16 v[112:127], v[212:215], v[20:23], v[112:127]
  v_exp_f32 v136, v136
  v_exp_f32 v137, v137
  v_exp_f32 v138, v138
  v_exp_f32 v139, v139
  v_smfmac_f32_32x32x32_bf16 v[96:111], v[168:171], v[128:135], v6
  v_exp_f32 v140, v140
  v_exp_f32 v141, v141
  v_exp_f32 v142, v142
  v_exp_f32 v143, v143
  v_exp_f32 v112, v112
  v_exp_f32 v113, v113
  v_smfmac_f32_32x32x32_bf16 v[96:111], v[172:175], v[136:143], v6
  v_exp_f32 v114, v114
  v_exp_f32 v115, v115
  v_exp_f32 v116, v116
  v_mfma_f32_32x32x16_bf16 v[128:143], v[208:211], v[24:27], 0
  s_mov_b32 s57, 49152
  buffer_load_dwordx4 v[144:147], v2, s[24:27], s57 offen offset:0 sc1
  v_exp_f32 v117, v117
  v_exp_f32 v118, v118
  v_exp_f32 v119, v119
  v_mfma_f32_32x32x16_bf16 v[128:143], v[212:215], v[28:31], v[128:143]
  v_exp_f32 v120, v120
  v_exp_f32 v121, v121
  v_exp_f32 v122, v122
  v_exp_f32 v123, v123
  v_smfmac_f32_32x32x32_bf16 v[48:63], v[216:219], v[112:119], v6
  v_exp_f32 v124, v124
  v_exp_f32 v125, v125
  v_exp_f32 v126, v126
  v_exp_f32 v127, v127
  v_exp_f32 v128, v128
  v_exp_f32 v129, v129
  v_smfmac_f32_32x32x32_bf16 v[48:63], v[220:223], v[120:127], v6
  v_exp_f32 v130, v130
  v_exp_f32 v131, v131
  v_exp_f32 v132, v132
  v_mfma_f32_32x32x16_bf16 v[112:127], v[208:211], v[32:35], 0
  buffer_load_dwordx4 v[148:151], v2, s[24:27], s57 offen offset:1024 sc1
  v_exp_f32 v133, v133
  v_exp_f32 v134, v134
  v_exp_f32 v135, v135
  v_mfma_f32_32x32x16_bf16 v[112:127], v[212:215], v[36:39], v[112:127]
  v_exp_f32 v136, v136
  v_exp_f32 v137, v137
  v_exp_f32 v138, v138
  v_exp_f32 v139, v139
  v_smfmac_f32_32x32x32_bf16 v[64:79], v[216:219], v[128:135], v6
  v_exp_f32 v140, v140
  v_exp_f32 v141, v141
  v_exp_f32 v142, v142
  v_exp_f32 v143, v143
  v_exp_f32 v112, v112
  v_exp_f32 v113, v113
  v_smfmac_f32_32x32x32_bf16 v[64:79], v[220:223], v[136:143], v6
  v_exp_f32 v114, v114
  v_exp_f32 v115, v115
  v_exp_f32 v116, v116
  v_mfma_f32_32x32x16_bf16 v[128:143], v[208:211], v[40:43], 0
  buffer_load_dwordx4 v[152:155], v2, s[24:27], s57 offen offset:2048 sc1
  v_exp_f32 v117, v117
  v_exp_f32 v118, v118
  v_exp_f32 v119, v119
  v_mfma_f32_32x32x16_bf16 v[128:143], v[212:215], v[44:47], v[128:143]
  v_exp_f32 v120, v120
  v_exp_f32 v121, v121
  v_exp_f32 v122, v122
  v_exp_f32 v123, v123
  v_smfmac_f32_32x32x32_bf16 v[80:95], v[216:219], v[112:119], v6
  v_exp_f32 v124, v124
  v_exp_f32 v125, v125
  v_exp_f32 v126, v126
  v_exp_f32 v127, v127
  v_exp_f32 v128, v128
  v_exp_f32 v129, v129
  v_smfmac_f32_32x32x32_bf16 v[80:95], v[220:223], v[120:127], v6
  v_exp_f32 v130, v130
  v_exp_f32 v131, v131
  v_exp_f32 v132, v132
  s_waitcnt vmcnt(11)
  v_mfma_f32_32x32x16_bf16 v[112:127], v[224:227], v[16:19], 0
  buffer_load_dwordx4 v[156:159], v2, s[24:27], s57 offen offset:3072 sc1
  v_exp_f32 v133, v133
  v_exp_f32 v134, v134
  v_exp_f32 v135, v135
  v_mfma_f32_32x32x16_bf16 v[112:127], v[228:231], v[20:23], v[112:127]
  v_exp_f32 v136, v136
  v_exp_f32 v137, v137
  v_exp_f32 v138, v138
  v_exp_f32 v139, v139
  v_smfmac_f32_32x32x32_bf16 v[96:111], v[216:219], v[128:135], v6
  v_exp_f32 v140, v140
  v_exp_f32 v141, v141
  v_exp_f32 v142, v142
  v_exp_f32 v143, v143
  v_exp_f32 v112, v112
  v_exp_f32 v113, v113
  v_smfmac_f32_32x32x32_bf16 v[96:111], v[220:223], v[136:143], v6
  v_exp_f32 v114, v114
  v_exp_f32 v115, v115
  v_exp_f32 v116, v116
  v_mfma_f32_32x32x16_bf16 v[128:143], v[224:227], v[24:27], 0
  s_mov_b32 s57, 53248
  buffer_load_dwordx4 v[160:163], v2, s[24:27], s57 offen offset:0 sc1
  v_exp_f32 v117, v117
  v_exp_f32 v118, v118
  v_exp_f32 v119, v119
  v_mfma_f32_32x32x16_bf16 v[128:143], v[228:231], v[28:31], v[128:143]
  v_exp_f32 v120, v120
  v_exp_f32 v121, v121
  v_exp_f32 v122, v122
  v_exp_f32 v123, v123
  v_smfmac_f32_32x32x32_bf16 v[48:63], v[232:235], v[112:119], v6
  v_exp_f32 v124, v124
  v_exp_f32 v125, v125
  v_exp_f32 v126, v126
  v_exp_f32 v127, v127
  v_exp_f32 v128, v128
  v_exp_f32 v129, v129
  v_smfmac_f32_32x32x32_bf16 v[48:63], v[236:239], v[120:127], v6
  v_exp_f32 v130, v130
  v_exp_f32 v131, v131
  v_exp_f32 v132, v132
  v_mfma_f32_32x32x16_bf16 v[112:127], v[224:227], v[32:35], 0
  buffer_load_dwordx4 v[164:167], v2, s[24:27], s57 offen offset:1024 sc1
  v_exp_f32 v133, v133
  v_exp_f32 v134, v134
  v_exp_f32 v135, v135
  v_mfma_f32_32x32x16_bf16 v[112:127], v[228:231], v[36:39], v[112:127]
  v_exp_f32 v136, v136
  v_exp_f32 v137, v137
  v_exp_f32 v138, v138
  v_exp_f32 v139, v139
  v_smfmac_f32_32x32x32_bf16 v[64:79], v[232:235], v[128:135], v6
  v_exp_f32 v140, v140
  v_exp_f32 v141, v141
  v_exp_f32 v142, v142
  v_exp_f32 v143, v143
  v_exp_f32 v112, v112
  v_exp_f32 v113, v113
  v_smfmac_f32_32x32x32_bf16 v[64:79], v[236:239], v[136:143], v6
  v_exp_f32 v114, v114
  v_exp_f32 v115, v115
  v_exp_f32 v116, v116
  v_mfma_f32_32x32x16_bf16 v[128:143], v[224:227], v[40:43], 0
  buffer_load_dwordx4 v[168:171], v2, s[24:27], s57 offen offset:2048 sc1
  v_exp_f32 v117, v117
  v_exp_f32 v118, v118
  v_exp_f32 v119, v119
  v_mfma_f32_32x32x16_bf16 v[128:143], v[228:231], v[44:47], v[128:143]
  v_exp_f32 v120, v120
  v_exp_f32 v121, v121
  v_exp_f32 v122, v122
  v_exp_f32 v123, v123
  v_smfmac_f32_32x32x32_bf16 v[80:95], v[232:235], v[112:119], v6
  v_exp_f32 v124, v124
  v_exp_f32 v125, v125
  v_exp_f32 v126, v126
  v_exp_f32 v127, v127
  v_exp_f32 v128, v128
  v_exp_f32 v129, v129
  v_smfmac_f32_32x32x32_bf16 v[80:95], v[236:239], v[120:127], v6
  v_exp_f32 v130, v130
  v_exp_f32 v131, v131
  v_exp_f32 v132, v132
  s_waitcnt vmcnt(11)
  v_mfma_f32_32x32x16_bf16 v[112:127], v[176:179], v[16:19], 0
  buffer_load_dwordx4 v[172:175], v2, s[24:27], s57 offen offset:3072 sc1
  v_exp_f32 v133, v133
  v_exp_f32 v134, v134
  v_exp_f32 v135, v135
  v_mfma_f32_32x32x16_bf16 v[112:127], v[180:183], v[20:23], v[112:127]
  v_exp_f32 v136, v136
  v_exp_f32 v137, v137
  v_exp_f32 v138, v138
  v_exp_f32 v139, v139
  v_smfmac_f32_32x32x32_bf16 v[96:111], v[232:235], v[128:135], v6
  v_exp_f32 v140, v140
  v_exp_f32 v141, v141
  v_exp_f32 v142, v142
  v_exp_f32 v143, v143
  v_exp_f32 v112, v112
  v_exp_f32 v113, v113
  v_smfmac_f32_32x32x32_bf16 v[96:111], v[236:239], v[136:143], v6
  v_exp_f32 v114, v114
  v_exp_f32 v115, v115
  v_exp_f32 v116, v116
  v_mfma_f32_32x32x16_bf16 v[128:143], v[176:179], v[24:27], 0
  s_mov_b32 s57, 57344
  buffer_load_dwordx4 v[208:211], v2, s[24:27], s57 offen offset:0 sc1
  v_exp_f32 v117, v117
  v_exp_f32 v118, v118
  v_exp_f32 v119, v119
  v_mfma_f32_32x32x16_bf16 v[128:143], v[180:183], v[28:31], v[128:143]
  v_exp_f32 v120, v120
  v_exp_f32 v121, v121
  v_exp_f32 v122, v122
  v_exp_f32 v123, v123
  v_smfmac_f32_32x32x32_bf16 v[48:63], v[184:187], v[112:119], v6
  v_exp_f32 v124, v124
  v_exp_f32 v125, v125
  v_exp_f32 v126, v126
  v_exp_f32 v127, v127
  v_exp_f32 v128, v128
  v_exp_f32 v129, v129
  v_smfmac_f32_32x32x32_bf16 v[48:63], v[188:191], v[120:127], v6
  v_exp_f32 v130, v130
  v_exp_f32 v131, v131
  v_exp_f32 v132, v132
  v_mfma_f32_32x32x16_bf16 v[112:127], v[176:179], v[32:35], 0
  buffer_load_dwordx4 v[212:215], v2, s[24:27], s57 offen offset:1024 sc1
  v_exp_f32 v133, v133
  v_exp_f32 v134, v134
  v_exp_f32 v135, v135
  v_mfma_f32_32x32x16_bf16 v[112:127], v[180:183], v[36:39], v[112:127]
  v_exp_f32 v136, v136
  v_exp_f32 v137, v137
  v_exp_f32 v138, v138
  v_exp_f32 v139, v139
  v_smfmac_f32_32x32x32_bf16 v[64:79], v[184:187], v[128:135], v6
  v_exp_f32 v140, v140
  v_exp_f32 v141, v141
  v_exp_f32 v142, v142
  v_exp_f32 v143, v143
  v_exp_f32 v112, v112
  v_exp_f32 v113, v113
  v_smfmac_f32_32x32x32_bf16 v[64:79], v[188:191], v[136:143], v6
  v_exp_f32 v114, v114
  v_exp_f32 v115, v115
  v_exp_f32 v116, v116
  v_mfma_f32_32x32x16_bf16 v[128:143], v[176:179], v[40:43], 0
  buffer_load_dwordx4 v[216:219], v2, s[24:27], s57 offen offset:2048 sc1
  v_exp_f32 v117, v117
  v_exp_f32 v118, v118
  v_exp_f32 v119, v119
  v_mfma_f32_32x32x16_bf16 v[128:143], v[180:183], v[44:47], v[128:143]
  v_exp_f32 v120, v120
  v_exp_f32 v121, v121
  v_exp_f32 v122, v122
  v_exp_f32 v123, v123
  v_smfmac_f32_32x32x32_bf16 v[80:95], v[184:187], v[112:119], v6
  v_exp_f32 v124, v124
  v_exp_f32 v125, v125
  v_exp_f32 v126, v126
  v_exp_f32 v127, v127
  v_exp_f32 v128, v128
  v_exp_f32 v129, v129
  v_smfmac_f32_32x32x32_bf16 v[80:95], v[188:191], v[120:127], v6
  v_exp_f32 v130, v130
  v_exp_f32 v131, v131
  v_exp_f32 v132, v132
  s_waitcnt vmcnt(11)
  v_mfma_f32_32x32x16_bf16 v[112:127], v[192:195], v[16:19], 0
  buffer_load_dwordx4 v[220:223], v2, s[24:27], s57 offen offset:3072 sc1
  v_exp_f32 v133, v133
  v_exp_f32 v134, v134
  v_exp_f32 v135, v135
  v_mfma_f32_32x32x16_bf16 v[112:127], v[196:199], v[20:23], v[112:127]
  v_exp_f32 v136, v136
  v_exp_f32 v137, v137
  v_exp_f32 v138, v138
  v_exp_f32 v139, v139
  v_smfmac_f32_32x32x32_bf16 v[96:111], v[184:187], v[128:135], v6
  v_exp_f32 v140, v140
  v_exp_f32 v141, v141
  v_exp_f32 v142, v142
  v_exp_f32 v143, v143
  v_exp_f32 v112, v112
  v_exp_f32 v113, v113
  v_smfmac_f32_32x32x32_bf16 v[96:111], v[188:191], v[136:143], v6
  v_exp_f32 v114, v114
  v_exp_f32 v115, v115
  v_exp_f32 v116, v116
  v_mfma_f32_32x32x16_bf16 v[128:143], v[192:195], v[24:27], 0
  s_mov_b32 s57, 61440
  buffer_load_dwordx4 v[224:227], v2, s[24:27], s57 offen offset:0 sc1
  v_exp_f32 v117, v117
  v_exp_f32 v118, v118
  v_exp_f32 v119, v119
  v_mfma_f32_32x32x16_bf16 v[128:143], v[196:199], v[28:31], v[128:143]
  v_exp_f32 v120, v120
  v_exp_f32 v121, v121
  v_exp_f32 v122, v122
  v_exp_f32 v123, v123
  v_smfmac_f32_32x32x32_bf16 v[48:63], v[200:203], v[112:119], v6
  v_exp_f32 v124, v124
  v_exp_f32 v125, v125
  v_exp_f32 v126, v126
  v_exp_f32 v127, v127
  v_exp_f32 v128, v128
  v_exp_f32 v129, v129
  v_smfmac_f32_32x32x32_bf16 v[48:63], v[204:207], v[120:127], v6
  v_exp_f32 v130, v130
  v_exp_f32 v131, v131
  v_exp_f32 v132, v132
  v_mfma_f32_32x32x16_bf16 v[112:127], v[192:195], v[32:35], 0
  buffer_load_dwordx4 v[228:231], v2, s[24:27], s57 offen offset:1024 sc1
  v_exp_f32 v133, v133
  v_exp_f32 v134, v134
  v_exp_f32 v135, v135
  v_mfma_f32_32x32x16_bf16 v[112:127], v[196:199], v[36:39], v[112:127]
  v_exp_f32 v136, v136
  v_exp_f32 v137, v137
  v_exp_f32 v138, v138
  v_exp_f32 v139, v139
  v_smfmac_f32_32x32x32_bf16 v[64:79], v[200:203], v[128:135], v6
  v_exp_f32 v140, v140
  v_exp_f32 v141, v141
  v_exp_f32 v142, v142
  v_exp_f32 v143, v143
  v_exp_f32 v112, v112
  v_exp_f32 v113, v113
  v_smfmac_f32_32x32x32_bf16 v[64:79], v[204:207], v[136:143], v6
  v_exp_f32 v114, v114
  v_exp_f32 v115, v115
  v_exp_f32 v116, v116
  v_mfma_f32_32x32x16_bf16 v[128:143], v[192:195], v[40:43], 0
  buffer_load_dwordx4 v[232:235], v2, s[24:27], s57 offen offset:2048 sc1
  v_exp_f32 v117, v117
  v_exp_f32 v118, v118
  v_exp_f32 v119, v119
  v_mfma_f32_32x32x16_bf16 v[128:143], v[196:199], v[44:47], v[128:143]
  v_exp_f32 v120, v120
  v_exp_f32 v121, v121
  v_exp_f32 v122, v122
  v_exp_f32 v123, v123
  v_smfmac_f32_32x32x32_bf16 v[80:95], v[200:203], v[112:119], v6
  v_exp_f32 v124, v124
  v_exp_f32 v125, v125
  v_exp_f32 v126, v126
  v_exp_f32 v127, v127
  v_exp_f32 v128, v128
  v_exp_f32 v129, v129
  v_smfmac_f32_32x32x32_bf16 v[80:95], v[204:207], v[120:127], v6
  v_exp_f32 v130, v130
  v_exp_f32 v131, v131
  v_exp_f32 v132, v132
  s_waitcnt vmcnt(11)
  v_mfma_f32_32x32x16_bf16 v[112:127], v[144:147], v[16:19], 0
  buffer_load_dwordx4 v[236:239], v2, s[24:27], s57 offen offset:3072 sc1
  v_exp_f32 v133, v133
  v_exp_f32 v134, v134
  v_exp_f32 v135, v135
  v_mfma_f32_32x32x16_bf16 v[112:127], v[148:151], v[20:23], v[112:127]
  v_exp_f32 v136, v136
  v_exp_f32 v137, v137
  v_exp_f32 v138, v138
  v_exp_f32 v139, v139
  v_smfmac_f32_32x32x32_bf16 v[96:111], v[200:203], v[128:135], v6
  v_exp_f32 v140, v140
  v_exp_f32 v141, v141
  v_exp_f32 v142, v142
  v_exp_f32 v143, v143
  v_exp_f32 v112, v112
  v_exp_f32 v113, v113
  v_smfmac_f32_32x32x32_bf16 v[96:111], v[204:207], v[136:143], v6
  v_exp_f32 v114, v114
  v_exp_f32 v115, v115
  v_exp_f32 v116, v116
  v_mfma_f32_32x32x16_bf16 v[128:143], v[144:147], v[24:27], 0
  v_exp_f32 v117, v117
  v_exp_f32 v118, v118
  v_exp_f32 v119, v119
  v_mfma_f32_32x32x16_bf16 v[128:143], v[148:151], v[28:31], v[128:143]
  v_exp_f32 v120, v120
  v_exp_f32 v121, v121
  v_exp_f32 v122, v122
  v_exp_f32 v123, v123
  v_smfmac_f32_32x32x32_bf16 v[48:63], v[152:155], v[112:119], v6
  v_exp_f32 v124, v124
  v_exp_f32 v125, v125
  v_exp_f32 v126, v126
  v_exp_f32 v127, v127
  v_exp_f32 v128, v128
  v_exp_f32 v129, v129
  v_smfmac_f32_32x32x32_bf16 v[48:63], v[156:159], v[120:127], v6
  v_exp_f32 v130, v130
  v_exp_f32 v131, v131
  v_exp_f32 v132, v132
  v_mfma_f32_32x32x16_bf16 v[112:127], v[144:147], v[32:35], 0
  v_exp_f32 v133, v133
  v_exp_f32 v134, v134
  v_exp_f32 v135, v135
  v_mfma_f32_32x32x16_bf16 v[112:127], v[148:151], v[36:39], v[112:127]
  v_exp_f32 v136, v136
  v_exp_f32 v137, v137
  v_exp_f32 v138, v138
  v_exp_f32 v139, v139
  v_smfmac_f32_32x32x32_bf16 v[64:79], v[152:155], v[128:135], v6
  v_exp_f32 v140, v140
  v_exp_f32 v141, v141
  v_exp_f32 v142, v142
  v_exp_f32 v143, v143
  v_exp_f32 v112, v112
  v_exp_f32 v113, v113
  v_smfmac_f32_32x32x32_bf16 v[64:79], v[156:159], v[136:143], v6
  v_exp_f32 v114, v114
  v_exp_f32 v115, v115
  v_exp_f32 v116, v116
  v_mfma_f32_32x32x16_bf16 v[128:143], v[144:147], v[40:43], 0
  v_exp_f32 v117, v117
  v_exp_f32 v118, v118
  v_exp_f32 v119, v119
  v_mfma_f32_32x32x16_bf16 v[128:143], v[148:151], v[44:47], v[128:143]
  v_exp_f32 v120, v120
  v_exp_f32 v121, v121
  v_exp_f32 v122, v122
  v_exp_f32 v123, v123
  v_smfmac_f32_32x32x32_bf16 v[80:95], v[152:155], v[112:119], v6
  v_exp_f32 v124, v124
  v_exp_f32 v125, v125
  v_exp_f32 v126, v126
  v_exp_f32 v127, v127
  v_exp_f32 v128, v128
  v_exp_f32 v129, v129
  v_smfmac_f32_32x32x32_bf16 v[80:95], v[156:159], v[120:127], v6
  v_exp_f32 v130, v130
  v_exp_f32 v131, v131
  v_exp_f32 v132, v132
  s_waitcnt vmcnt(8)
  v_mfma_f32_32x32x16_bf16 v[112:127], v[160:163], v[16:19], 0
  v_exp_f32 v133, v133
  v_exp_f32 v134, v134
  v_exp_f32 v135, v135
  v_mfma_f32_32x32x16_bf16 v[112:127], v[164:167], v[20:23], v[112:127]
  v_exp_f32 v136, v136
  v_exp_f32 v137, v137
  v_exp_f32 v138, v138
  v_exp_f32 v139, v139
  v_smfmac_f32_32x32x32_bf16 v[96:111], v[152:155], v[128:135], v6
  v_exp_f32 v140, v140
  v_exp_f32 v141, v141
  v_exp_f32 v142, v142
  v_exp_f32 v143, v143
  v_exp_f32 v112, v112
  v_exp_f32 v113, v113
  v_smfmac_f32_32x32x32_bf16 v[96:111], v[156:159], v[136:143], v6
  v_exp_f32 v114, v114
  v_exp_f32 v115, v115
  v_exp_f32 v116, v116
  s_waitcnt vmcnt(4)
  v_mfma_f32_32x32x16_bf16 v[128:143], v[208:211], v[16:19], 0
  v_exp_f32 v117, v117
  v_exp_f32 v118, v118
  v_exp_f32 v119, v119
  v_mfma_f32_32x32x16_bf16 v[128:143], v[212:215], v[20:23], v[128:143]
  v_exp_f32 v120, v120
  v_exp_f32 v121, v121
  v_exp_f32 v122, v122
  v_exp_f32 v123, v123
  v_smfmac_f32_32x32x32_bf16 v[48:63], v[168:171], v[112:119], v6
  v_exp_f32 v124, v124
  v_exp_f32 v125, v125
  v_exp_f32 v126, v126
  v_exp_f32 v127, v127
  v_exp_f32 v128, v128
  v_exp_f32 v129, v129
  v_smfmac_f32_32x32x32_bf16 v[48:63], v[172:175], v[120:127], v6
  v_exp_f32 v130, v130
  v_exp_f32 v131, v131
  v_exp_f32 v132, v132
  s_waitcnt vmcnt(0)
  v_mfma_f32_32x32x16_bf16 v[112:127], v[224:227], v[16:19], 0
  v_exp_f32 v133, v133
  v_exp_f32 v134, v134
  v_exp_f32 v135, v135
  v_mfma_f32_32x32x16_bf16 v[112:127], v[228:231], v[20:23], v[112:127]
  v_exp_f32 v136, v136
  v_exp_f32 v137, v137
  v_exp_f32 v138, v138
  v_exp_f32 v139, v139
  v_smfmac_f32_32x32x32_bf16 v[48:63], v[216:219], v[128:135], v6
  v_exp_f32 v140, v140
  v_exp_f32 v141, v141
  v_exp_f32 v142, v142
  v_exp_f32 v143, v143
  v_exp_f32 v112, v112
  v_exp_f32 v113, v113
  v_smfmac_f32_32x32x32_bf16 v[48:63], v[220:223], v[136:143], v6
  v_exp_f32 v114, v114
  v_exp_f32 v115, v115
  v_exp_f32 v116, v116
  v_mfma_f32_32x32x16_bf16 v[128:143], v[160:163], v[32:35], 0
  v_exp_f32 v117, v117
  v_exp_f32 v118, v118
  v_exp_f32 v119, v119
  v_mfma_f32_32x32x16_bf16 v[128:143], v[164:167], v[36:39], v[128:143]
  v_exp_f32 v120, v120
  ds_read_b32 v13, v255 offset:16
  v_exp_f32 v121, v121
  v_exp_f32 v122, v122
  v_exp_f32 v123, v123
  v_smfmac_f32_32x32x32_bf16 v[48:63], v[232:235], v[112:119], v6
  v_exp_f32 v124, v124
  v_exp_f32 v125, v125
  v_exp_f32 v126, v126
  v_exp_f32 v127, v127
  v_exp_f32 v128, v128
  v_exp_f32 v129, v129
  v_smfmac_f32_32x32x32_bf16 v[48:63], v[236:239], v[120:127], v6
  v_exp_f32 v130, v130
  v_exp_f32 v131, v131
  v_exp_f32 v132, v132
  v_mfma_f32_32x32x16_bf16 v[112:127], v[208:211], v[32:35], 0
  v_exp_f32 v133, v133
  v_exp_f32 v134, v134
  v_exp_f32 v135, v135
  v_mfma_f32_32x32x16_bf16 v[112:127], v[212:215], v[36:39], v[112:127]
  v_exp_f32 v136, v136
  s_waitcnt lgkmcnt(0)
  v_cmp_gt_u32 vcc, 4, v13
  s_cbranch_vccnz L_mspina
L_moka:
  v_exp_f32 v137, v137
  v_exp_f32 v138, v138
  v_exp_f32 v139, v139
  v_smfmac_f32_32x32x32_bf16 v[80:95], v[168:171], v[128:135], v6
  v_exp_f32 v140, v140
  ds_write_b128 v3, v[48:51] offset:16384
  v_exp_f32 v141, v141
  ds_write_b128 v3, v[52:55] offset:17408
  v_exp_f32 v142, v142
  v_exp_f32 v143, v143
  v_exp_f32 v112, v112
  ds_write_b128 v3, v[56:59] offset:18432
  v_exp_f32 v113, v113
  v_smfmac_f32_32x32x32_bf16 v[80:95], v[172:175], v[136:143], v6
  v_exp_f32 v114, v114
  v_exp_f32 v115, v115
  ds_write_b128 v3, v[60:63] offset:19456
  v_exp_f32 v116, v116
  v_mfma_f32_32x32x16_bf16 v[128:143], v[224:227], v[32:35], 0
  v_exp_f32 v117, v117
  v_exp_f32 v118, v118
  s_mov_b64 exec, 1
  ds_add_u32 v255, v5 offset:20
  s_mov_b64 exec, -1
  v_exp_f32 v119, v119
  v_mfma_f32_32x32x16_bf16 v[128:143], v[228:231], v[36:39], v[128:143]
  v_exp_f32 v120, v120
  v_exp_f32 v121, v121
  v_exp_f32 v122, v122
  v_exp_f32 v123, v123
  v_smfmac_f32_32x32x32_bf16 v[80:95], v[216:219], v[112:119], v6
  v_exp_f32 v124, v124
  v_exp_f32 v125, v125
  v_exp_f32 v126, v126
  v_exp_f32 v127, v127
  v_exp_f32 v128, v128
  v_exp_f32 v129, v129
  v_smfmac_f32_32x32x32_bf16 v[80:95], v[220:223], v[120:127], v6
  v_exp_f32 v130, v130
  v_exp_f32 v131, v131
  v_exp_f32 v132, v132
  v_mfma_f32_32x32x16_bf16 v[112:127], v[160:163], v[24:27], 0
  v_exp_f32 v133, v133
  v_exp_f32 v134, v134
  v_exp_f32 v135, v135
  v_mfma_f32_32x32x16_bf16 v[112:127], v[164:167], v[28:31], v[112:127]
  v_exp_f32 v136, v136
  v_exp_f32 v137, v137
  v_exp_f32 v138, v138
  v_exp_f32 v139, v139
  v_smfmac_f32_32x32x32_bf16 v[80:95], v[232:235], v[128:135], v6
  v_exp_f32 v140, v140
  v_exp_f32 v141, v141
  v_exp_f32 v142, v142
  v_exp_f32 v143, v143
  v_exp_f32 v112, v112
  v_exp_f32 v113, v113
  v_smfmac_f32_32x32x32_bf16 v[80:95], v[236:239], v[136:143], v6
  v_exp_f32 v114, v114
  v_exp_f32 v115, v115
  v_exp_f32 v116, v116
  v_mfma_f32_32x32x16_bf16 v[128:143], v[208:211], v[24:27], 0
  v_exp_f32 v117, v117
  v_exp_f32 v118, v118
  v_exp_f32 v119, v119
  v_mfma_f32_32x32x16_bf16 v[128:143], v[212:215], v[28:31], v[128:143]
  v_exp_f32 v120, v120
  v_exp_f32 v121, v121
  v_exp_f32 v122, v122
  v_exp_f32 v123, v123
  v_smfmac_f32_32x32x32_bf16 v[64:79], v[168:171], v[112:119], v6
  v_exp_f32 v124, v124
  ds_write_b128 v3, v[80:83] offset:0
  v_exp_f32 v125, v125
  ds_write_b128 v3, v[84:87] offset:1024
  v_exp_f32 v126, v126
  v_exp_f32 v127, v127
  v_exp_f32 v128, v128
  ds_write_b128 v3, v[88:91] offset:2048
  v_exp_f32 v129, v129
  v_smfmac_f32_32x32x32_bf16 v[64:79], v[172:175], v[120:127], v6
  v_exp_f32 v130, v130
  v_exp_f32 v131, v131
  ds_write_b128 v3, v[92:95] offset:3072
  v_exp_f32 v132, v132
  v_mfma_f32_32x32x16_bf16 v[112:127], v[224:227], v[24:27], 0
  v_exp_f32 v133, v133
  v_exp_f32 v134, v134
  s_mov_b64 exec, 1
  ds_add_u32 v255, v5 offset:24
  s_mov_b64 exec, -1
  v_exp_f32 v135, v135
  v_mfma_f32_32x32x16_bf16 v[112:127], v[228:231], v[28:31], v[112:127]
  v_exp_f32 v136, v136
  v_exp_f32 v137, v137
  v_exp_f32 v138, v138
  v_exp_f32 v139, v139
  v_smfmac_f32_32x32x32_bf16 v[64:79], v[216:219], v[128:135], v6
  v_exp_f32 v140, v140
  v_exp_f32 v141, v141
  v_exp_f32 v142, v142
  v_exp_f32 v143, v143
  v_exp_f32 v112, v112
  v_exp_f32 v113, v113
  v_smfmac_f32_32x32x32_bf16 v[64:79], v[220:223], v[136:143], v6
  v_exp_f32 v114, v114
  v_exp_f32 v115, v115
  v_exp_f32 v116, v116
  v_mfma_f32_32x32x16_bf16 v[128:143], v[160:163], v[40:43], 0
  v_exp_f32 v117, v117
  v_exp_f32 v118, v118
  v_exp_f32 v119, v119
  v_mfma_f32_32x32x16_bf16 v[128:143], v[164:167], v[44:47], v[128:143]
  v_exp_f32 v120, v120
  v_exp_f32 v121, v121
  v_exp_f32 v122, v122
  v_exp_f32 v123, v123
  v_smfmac_f32_32x32x32_bf16 v[64:79], v[232:235], v[112:119], v6
  v_exp_f32 v124, v124
  v_exp_f32 v125, v125
  v_exp_f32 v126, v126
  v_exp_f32 v127, v127
  v_exp_f32 v128, v128
  v_exp_f32 v129, v129
  v_smfmac_f32_32x32x32_bf16 v[64:79], v[236:239], v[120:127], v6
  v_exp_f32 v130, v130
  v_exp_f32 v131, v131
  v_exp_f32 v132, v132
  v_mfma_f32_32x32x16_bf16 v[112:127], v[208:211], v[40:43], 0
  v_exp_f32 v133, v133
  v_exp_f32 v134, v134
  v_exp_f32 v135, v135
  v_mfma_f32_32x32x16_bf16 v[112:127], v[212:215], v[44:47], v[112:127]
  v_exp_f32 v136, v136
  v_exp_f32 v137, v137
  v_exp_f32 v138, v138
  v_exp_f32 v139, v139
  v_smfmac_f32_32x32x32_bf16 v[96:111], v[168:171], v[128:135], v6
  v_exp_f32 v140, v140
  ds_write_b128 v3, v[64:67] offset:32768
  v_exp_f32 v141, v141
  ds_write_b128 v3, v[68:71] offset:33792
  v_exp_f32 v142, v142
  v_exp_f32 v143, v143
  v_exp_f32 v112, v112
  ds_write_b128 v3, v[72:75] offset:34816
  v_exp_f32 v113, v113
  v_smfmac_f32_32x32x32_bf16 v[96:111], v[172:175], v[136:143], v6
  v_exp_f32 v114, v114
  v_exp_f32 v115, v115
  ds_write_b128 v3, v[76:79] offset:35840
  v_exp_f32 v116, v116
  v_mfma_f32_32x32x16_bf16 v[128:143], v[224:227], v[40:43], 0
  v_exp_f32 v117, v117
  s_mov_b64 exec, 1
  ds_add_u32 v255, v5 offset:28
  s_mov_b64 exec, -1
  v_exp_f32 v118, v118
  v_exp_f32 v119, v119
  v_mfma_f32_32x32x16_bf16 v[128:143], v[228:231], v[44:47], v[128:143]
  v_exp_f32 v120, v120
  v_exp_f32 v121, v121
  v_exp_f32 v122, v122
  v_exp_f32 v123, v123
  v_smfmac_f32_32x32x32_bf16 v[96:111], v[216:219], v[112:119], v6
  v_exp_f32 v124, v124
  v_exp_f32 v125, v125
  v_exp_f32 v126, v126
  ds_read_b32 v13, v255 offset:32
  v_exp_f32 v127, v127
  v_exp_f32 v128, v128
  v_exp_f32 v129, v129
  v_smfmac_f32_32x32x32_bf16 v[96:111], v[220:223], v[120:127], v6
  v_exp_f32 v130, v130
  v_exp_f32 v131, v131
  v_exp_f32 v132, v132
  v_exp_f32 v133, v133
  v_exp_f32 v134, v134
  v_exp_f32 v135, v135
  v_exp_f32 v136, v136
  s_waitcnt lgkmcnt(0)
  v_cmp_gt_u32 vcc, 4, v13
  s_cbranch_vccnz L_mspinf
L_mokf:
  v_exp_f32 v137, v137
  v_exp_f32 v138, v138
  v_exp_f32 v139, v139
  v_smfmac_f32_32x32x32_bf16 v[96:111], v[232:235], v[128:135], v6
  v_exp_f32 v140, v140
  v_exp_f32 v141, v141
  v_exp_f32 v142, v142
  v_exp_f32 v143, v143
  s_nop 1
  v_smfmac_f32_32x32x32_bf16 v[96:111], v[236:239], v[136:143], v6
  ds_read_b32 v13, v255 offset:36
  s_add_u32 s15, s5, 4096
  s_waitcnt lgkmcnt(0)
  v_cmp_eq_u32 vcc, 0, v13
  s_nop 7
  ds_write_b128 v3, v[96:99] offset:16384
  ds_write_b128 v3, v[100:103] offset:17408
  ds_write_b128 v3, v[104:107] offset:18432
  ds_write_b128 v3, v[108:111] offset:19456
  s_cbranch_vccnz L_m_late
  buffer_load_dwordx4 v[176:179], v1, s[24:27], s5 offen offset:0 sc1
  buffer_load_dwordx4 v[180:183], v1, s[24:27], s5 offen offset:1024 sc1
  buffer_load_dwordx4 v[184:187], v1, s[24:27], s5 offen offset:2048 sc1
  buffer_load_dwordx4 v[188:191], v1, s[24:27], s5 offen offset:3072 sc1
  buffer_load_dwordx4 v[192:195], v1, s[24:27], s15 offen offset:0 sc1
  buffer_load_dwordx4 v[196:199], v1, s[24:27], s15 offen offset:1024 sc1
  buffer_load_dwordx4 v[200:203], v1, s[24:27], s15 offen offset:2048 sc1
  buffer_load_dwordx4 v[204:207], v1, s[24:27], s15 offen offset:3072 sc1
L_m_late:
  s_waitcnt lgkmcnt(0)
  s_setprio 0
  s_barrier
  s_cbranch_vccz L_m_go
  buffer_load_dwordx4 v[176:179], v1, s[24:27], s5 offen offset:0 sc1
  buffer_load_dwordx4 v[180:183], v1, s[24:27], s5 offen offset:1024 sc1
  buffer_load_dwordx4 v[184:187], v1, s[24:27], s5 offen offset:2048 sc1
  buffer_load_dwordx4 v[188:191], v1, s[24:27], s5 offen offset:3072 sc1
  buffer_load_dwordx4 v[192:195], v1, s[24:27], s15 offen offset:0 sc1
  buffer_load_dwordx4 v[196:199], v1, s[24:27], s15 offen offset:1024 sc1
  buffer_load_dwordx4 v[200:203], v1, s[24:27], s15 offen offset:2048 sc1
  buffer_load_dwordx4 v[204:207], v1, s[24:27], s15 offen offset:3072 sc1
L_m_go:
  s_waitcnt vmcnt(0)
L_tail:
  s_setprio 0
  s_cmp_eq_u32 s51, 0
  s_cbranch_scc1 L_tp
  s_setprio 1
L_tp:
  s_cmp_eq_u32 s63, 7
  s_cbranch_scc1 L_fini
  ds_read_b64_tr_b16 v[112:113], v240 offset:0
  ds_read_b64_tr_b16 v[114:115], v240 offset:1024
  ds_read_b64_tr_b16 v[116:117], v241 offset:0
  ds_read_b64_tr_b16 v[118:119], v241 offset:1024
  ds_read_b64_tr_b16 v[120:121], v240 offset:2048
  ds_read_b64_tr_b16 v[122:123], v242 offset:3072
  ds_read_b64_tr_b16 v[124:125], v241 offset:2048
  ds_read_b64_tr_b16 v[126:127], v243 offset:3072
  ds_read_b64_tr_b16 v[128:129], v240 offset:3584
  ds_read_b64_tr_b16 v[130:131], v240 offset:4608
  ds_read_b64_tr_b16 v[132:133], v241 offset:3584
  ds_read_b64_tr_b16 v[134:135], v241 offset:4608
  s_waitcnt vmcnt(1)
  s_add_u32 s5, s5, 32768
  s_add_u32 s15, s5, 4096
  s_mov_b32 s3, 200000
  s_waitcnt lgkmcnt(8)
  v_mfma_f32_32x32x16_bf16 v[16:31], v[112:115], v[176:179], 0
  v_mfma_f32_32x32x16_bf16 v[32:47], v[116:119], v[176:179], 0
  ds_read_b64_tr_b16 v[136:137], v240 offset:5632
  ds_read_b64_tr_b16 v[138:139], v242 offset:6656
  ds_read_b64_tr_b16 v[140:141], v241 offset:5632
  ds_read_b64_tr_b16 v[142:143], v243 offset:6656
  s_waitcnt lgkmcnt(8)
  v_mfma_f32_32x32x16_bf16 v[16:31], v[120:123], v[180:183], v[16:31]
  v_mfma_f32_32x32x16_bf16 v[32:47], v[124:127], v[180:183], v[32:47]
  ds_read_b64_tr_b16 v[112:113], v240 offset:7168
  ds_read_b64_tr_b16 v[114:115], v240 offset:8192
  ds_read_b64_tr_b16 v[116:117], v241 offset:7168
  ds_read_b64_tr_b16 v[118:119], v241 offset:8192
  s_waitcnt lgkmcnt(8)
  v_mfma_f32_32x32x16_bf16 v[16:31], v[128:131], v[184:187], v[16:31]
  v_mfma_f32_32x32x16_bf16 v[32:47], v[132:135], v[184:187], v[32:47]
  ds_read_b64_tr_b16 v[120:121], v240 offset:9216
  ds_read_b64_tr_b16 v[122:123], v242 offset:10240
  ds_read_b64_tr_b16 v[124:125], v241 offset:9216
  ds_read_b64_tr_b16 v[126:127], v243 offset:10240
  s_cmp_eq_u32 s51, 0
  s_cbranch_scc0 L_nob_41
  buffer_load_dwordx4 v[208:211], v1, s[24:27], s5 offen offset:0 sc1
  buffer_load_dwordx4 v[212:215], v1, s[24:27], s5 offen offset:1024 sc1
  buffer_load_dwordx4 v[216:219], v1, s[24:27], s5 offen offset:2048 sc1
  buffer_load_dwordx4 v[220:223], v1, s[24:27], s5 offen offset:3072 sc1
  buffer_load_dwordx4 v[224:227], v1, s[24:27], s15 offen offset:0 sc1
  buffer_load_dwordx4 v[228:231], v1, s[24:27], s15 offen offset:1024 sc1
  buffer_load_dwordx4 v[232:235], v1, s[24:27], s15 offen offset:2048 sc1
  buffer_load_dwordx4 v[236:239], v1, s[24:27], s15 offen offset:3072 sc1
L_nob_41:
  s_waitcnt lgkmcnt(8)
  v_mfma_f32_32x32x16_bf16 v[16:31], v[136:139], v[188:191], v[16:31]
  v_mfma_f32_32x32x16_bf16 v[32:47], v[140:143], v[188:191], v[32:47]
  ds_read_b64_tr_b16 v[128:129], v240 offset:10752
  ds_read_b64_tr_b16 v[130:131], v240 offset:11776
  ds_read_b64_tr_b16 v[132:133], v241 offset:10752
  ds_read_b64_tr_b16 v[134:135], v241 offset:11776
  s_waitcnt lgkmcnt(8)
  v_mfma_f32_32x32x16_bf16 v[16:31], v[112:115], v[192:195], v[16:31]
  v_mfma_f32_32x32x16_bf16 v[32:47], v[116:119], v[192:195], v[32:47]
  ds_read_b64_tr_b16 v[136:137], v240 offset:12800
  ds_read_b64_tr_b16 v[138:139], v242 offset:13824
  ds_read_b64_tr_b16 v[140:141], v241 offset:12800
  ds_read_b64_tr_b16 v[142:143], v243 offset:13824
  s_waitcnt lgkmcnt(8)
  v_mfma_f32_32x32x16_bf16 v[16:31], v[120:123], v[196:199], v[16:31]
  v_mfma_f32_32x32x16_bf16 v[32:47], v[124:127], v[196:199], v[32:47]
  v_add_u32 v240, 4294909952, v240
  v_add_u32 v241, 4294909952, v241
  v_add_u32 v242, 4294909952, v242
  v_add_u32 v243, 4294909952, v243
  ds_read_b64_tr_b16 v[112:113], v240 offset:0
  ds_read_b64_tr_b16 v[114:115], v240 offset:1024
  ds_read_b64_tr_b16 v[116:117], v241 offset:0
  ds_read_b64_tr_b16 v[118:119], v241 offset:1024
  s_waitcnt lgkmcnt(8)
  v_mfma_f32_32x32x16_bf16 v[16:31], v[128:131], v[200:203], v[16:31]
  v_mfma_f32_32x32x16_bf16 v[32:47], v[132:135], v[200:203], v[32:47]
  ds_read_b64_tr_b16 v[120:121], v240 offset:2048
  ds_read_b64_tr_b16 v[122:123], v242 offset:3072
  ds_read_b64_tr_b16 v[124:125], v241 offset:2048
  ds_read_b64_tr_b16 v[126:127], v243 offset:3072
  s_waitcnt lgkmcnt(8)
  v_mfma_f32_32x32x16_bf16 v[16:31], v[136:139], v[204:207], v[16:31]
  v_mfma_f32_32x32x16_bf16 v[32:47], v[140:143], v[204:207], v[32:47]
  ds_read_b64_tr_b16 v[128:129], v240 offset:3584
  ds_read_b64_tr_b16 v[130:131], v240 offset:4608
  ds_read_b64_tr_b16 v[132:133], v241 offset:3584
  ds_read_b64_tr_b16 v[134:135], v241 offset:4608
  s_barrier
  s_cmp_eq_u32 s51, 1
  s_cbranch_scc0 L_nob_42
  buffer_load_dwordx4 v[208:211], v1, s[24:27], s5 offen offset:0 sc1
  buffer_load_dwordx4 v[212:215], v1, s[24:27], s5 offen offset:1024 sc1
  buffer_load_dwordx4 v[216:219], v1, s[24:27], s5 offen offset:2048 sc1
  buffer_load_dwordx4 v[220:223], v1, s[24:27], s5 offen offset:3072 sc1
  buffer_load_dwordx4 v[224:227], v1, s[24:27], s15 offen offset:0 sc1
  buffer_load_dwordx4 v[228:231], v1, s[24:27], s15 offen offset:1024 sc1
  buffer_load_dwordx4 v[232:235], v1, s[24:27], s15 offen offset:2048 sc1
  buffer_load_dwordx4 v[236:239], v1, s[24:27], s15 offen offset:3072 sc1
L_nob_42:
L_ob0:
  s_waitcnt vmcnt(7)
  v_max3_u32 v10, v208, v209, v210
  v_max_u32 v10, v10, v211
  v_cmp_eq_u32 vcc, -1, v10
  s_cbranch_vccnz L_retry0
L_ob0_go:
  s_waitcnt lgkmcnt(8)
  v_mfma_f32_32x32x16_bf16 v[16:31], v[112:115], v[208:211], v[16:31]
  v_mfma_f32_32x32x16_bf16 v[32:47], v[116:119], v[208:211], v[32:47]
  ds_read_b64_tr_b16 v[136:137], v240 offset:5632
  ds_read_b64_tr_b16 v[138:139], v242 offset:6656
  ds_read_b64_tr_b16 v[140:141], v241 offset:5632
  ds_read_b64_tr_b16 v[142:143], v243 offset:6656
L_ob1:
  s_waitcnt vmcnt(6)
  v_max3_u32 v10, v212, v213, v214
  v_max_u32 v10, v10, v215
  v_cmp_eq_u32 vcc, -1, v10
  s_cbranch_vccnz L_retry1
L_ob1_go:
  s_waitcnt lgkmcnt(8)
  v_mfma_f32_32x32x16_bf16 v[16:31], v[120:123], v[212:215], v[16:31]
  v_mfma_f32_32x32x16_bf16 v[32:47], v[124:127], v[212:215], v[32:47]
  ds_read_b64_tr_b16 v[112:113], v240 offset:7168
  ds_read_b64_tr_b16 v[114:115], v240 offset:8192
  ds_read_b64_tr_b16 v[116:117], v241 offset:7168
  ds_read_b64_tr_b16 v[118:119], v241 offset:8192
L_ob2:
  s_waitcnt vmcnt(5)
  v_max3_u32 v10, v216, v217, v218
  v_max_u32 v10, v10, v219
  v_cmp_eq_u32 vcc, -1, v10
  s_cbranch_vccnz L_retry2
L_ob2_go:
  s_waitcnt lgkmcnt(8)
  v_mfma_f32_32x32x16_bf16 v[16:31], v[128:131], v[216:219], v[16:31]
  v_mfma_f32_32x32x16_bf16 v[32:47], v[132:135], v[216:219], v[32:47]
  ds_read_b64_tr_b16 v[120:121], v240 offset:9216
  ds_read_b64_tr_b16 v[122:123], v242 offset:10240
  ds_read_b64_tr_b16 v[124:125], v241 offset:9216
  ds_read_b64_tr_b16 v[126:127], v243 offset:10240
L_ob3:
  s_waitcnt vmcnt(4)
  v_max3_u32 v10, v220, v221, v222
  v_max_u32 v10, v10, v223
  v_cmp_eq_u32 vcc, -1, v10
  s_cbranch_vccnz L_retry3
L_ob3_go:
  s_waitcnt lgkmcnt(8)
  v_mfma_f32_32x32x16_bf16 v[16:31], v[136:139], v[220:223], v[16:31]
  v_mfma_f32_32x32x16_bf16 v[32:47], v[140:143], v[220:223], v[32:47]
  ds_read_b64_tr_b16 v[128:129], v240 offset:10752
  ds_read_b64_tr_b16 v[130:131], v240 offset:11776
  ds_read_b64_tr_b16 v[132:133], v241 offset:10752
  ds_read_b64_tr_b16 v[134:135], v241 offset:11776
L_ob4:
  s_waitcnt vmcnt(3)
  v_max3_u32 v10, v224, v225, v226
  v_max_u32 v10, v10, v227
  v_cmp_eq_u32 vcc, -1, v10
  s_cbranch_vccnz L_retry4
L_ob4_go:
  s_waitcnt lgkmcnt(8)
  v_mfma_f32_32x32x16_bf16 v[16:31], v[112:115], v[224:227], v[16:31]
  v_mfma_f32_32x32x16_bf16 v[32:47], v[116:119], v[224:227], v[32:47]
  ds_read_b64_tr_b16 v[136:137], v240 offset:12800
  ds_read_b64_tr_b16 v[138:139], v242 offset:13824
  ds_read_b64_tr_b16 v[140:141], v241 offset:12800
  ds_read_b64_tr_b16 v[142:143], v243 offset:13824
L_ob5:
  s_waitcnt vmcnt(2)
  v_max3_u32 v10, v228, v229, v230
  v_max_u32 v10, v10, v231
  v_cmp_eq_u32 vcc, -1, v10
  s_cbranch_vccnz L_retry5
L_ob5_go:
  s_waitcnt lgkmcnt(8)
  v_mfma_f32_32x32x16_bf16 v[16:31], v[120:123], v[228:231], v[16:31]
  v_mfma_f32_32x32x16_bf16 v[32:47], v[124:127], v[228:231], v[32:47]
L_ob6:
  s_waitcnt vmcnt(1)
  v_max3_u32 v10, v232, v233, v234
  v_max_u32 v10, v10, v235
  v_cmp_eq_u32 vcc, -1, v10
  s_cbranch_vccnz L_retry6
L_ob6_go:
  s_waitcnt lgkmcnt(4)
  v_mfma_f32_32x32x16_bf16 v[16:31], v[128:131], v[232:235], v[16:31]
  v_mfma_f32_32x32x16_bf16 v[32:47], v[132:135], v[232:235], v[32:47]
L_ob7:
  s_waitcnt vmcnt(0)
  v_max3_u32 v10, v236, v237, v238
  v_max_u32 v10, v10, v239
  v_cmp_eq_u32 vcc, -1, v10
  s_cbranch_vccnz L_retry7
L_ob7_go:
  s_waitcnt lgkmcnt(0)
  v_mfma_f32_32x32x16_bf16 v[16:31], v[136:139], v[236:239], v[16:31]
  v_mfma_f32_32x32x16_bf16 v[32:47], v[140:143], v[236:239], v[32:47]
  s_cmp_eq_u32 s52, 1
  s_cbranch_scc1 L_fin3_1
  s_cmp_eq_u32 s52, 2
  s_cbranch_scc1 L_fin3_2
  s_cmp_eq_u32 s52, 3
  s_cbranch_scc1 L_fin3_3
  s_nop 9
  ds_write_b128 v245, v[24:27] offset:6144
  ds_write_b128 v245, v[28:31] offset:7168
  ds_write_b128 v245, v[32:35] offset:12288
  ds_write_b128 v245, v[36:39] offset:13312
  ds_write_b128 v245, v[40:43] offset:18432
  ds_write_b128 v245, v[44:47] offset:19456
  s_waitcnt lgkmcnt(0)
  s_barrier
  ds_read_b128 v[48:51], v245 offset:0
  ds_read_b128 v[52:55], v245 offset:1024
  ds_read_b128 v[56:59], v245 offset:2048
  ds_read_b128 v[60:63], v245 offset:3072
  ds_read_b128 v[64:67], v245 offset:4096
  ds_read_b128 v[68:71], v245 offset:5120
  s_waitcnt lgkmcnt(4)
  v_pk_add_f32 v[48:49], v[48:49], v[16:17]
  v_pk_add_f32 v[50:51], v[50:51], v[18:19]
  v_pk_add_f32 v[52:53], v[52:53], v[20:21]
  v_pk_add_f32 v[54:55], v[54:55], v[22:23]
  s_branch L_fin3_join
L_fin3_1:
  s_nop 9
  ds_write_b128 v245, v[16:19] offset:0
  ds_write_b128 v245, v[20:23] offset:1024
  ds_write_b128 v245, v[32:35] offset:14336
  ds_write_b128 v245, v[36:39] offset:15360
  ds_write_b128 v245, v[40:43] offset:20480
  ds_write_b128 v245, v[44:47] offset:21504
  s_waitcnt lgkmcnt(0)
  s_barrier
  ds_read_b128 v[48:51], v245 offset:6144
  ds_read_b128 v[52:55], v245 offset:7168
  ds_read_b128 v[56:59], v245 offset:8192
  ds_read_b128 v[60:63], v245 offset:9216
  ds_read_b128 v[64:67], v245 offset:10240
  ds_read_b128 v[68:71], v245 offset:11264
  s_waitcnt lgkmcnt(4)
  v_pk_add_f32 v[48:49], v[48:49], v[24:25]
  v_pk_add_f32 v[50:51], v[50:51], v[26:27]
  v_pk_add_f32 v[52:53], v[52:53], v[28:29]
  v_pk_add_f32 v[54:55], v[54:55], v[30:31]
  s_branch L_fin3_join
L_fin3_2:
  s_nop 9
  ds_write_b128 v245, v[16:19] offset:2048
  ds_write_b128 v245, v[20:23] offset:3072
  ds_write_b128 v245, v[24:27] offset:8192
  ds_write_b128 v245, v[28:31] offset:9216
  ds_write_b128 v245, v[40:43] offset:22528
  ds_write_b128 v245, v[44:47] offset:23552
  s_waitcnt lgkmcnt(0)
  s_barrier
  ds_read_b128 v[48:51], v245 offset:12288
  ds_read_b128 v[52:55], v245 offset:13312
  ds_read_b128 v[56:59], v245 offset:14336
  ds_read_b128 v[60:63], v245 offset:15360
  ds_read_b128 v[64:67], v245 offset:16384
  ds_read_b128 v[68:71], v245 offset:17408
  s_waitcnt lgkmcnt(4)
  v_pk_add_f32 v[48:49], v[48:49], v[32:33]
  v_pk_add_f32 v[50:51], v[50:51], v[34:35]
  v_pk_add_f32 v[52:53], v[52:53], v[36:37]
  v_pk_add_f32 v[54:55], v[54:55], v[38:39]
  s_branch L_fin3_join
L_fin3_3:
  s_nop 9
  ds_write_b128 v245, v[16:19] offset:4096
  ds_write_b128 v245, v[20:23] offset:5120
  ds_write_b128 v245, v[24:27] offset:10240
  ds_write_b128 v245, v[28:31] offset:11264
  ds_write_b128 v245, v[32:35] offset:16384
  ds_write_b128 v245, v[36:39] offset:17408
  s_waitcnt lgkmcnt(0)
  s_barrier
  ds_read_b128 v[48:51], v245 offset:18432
  ds_read_b128 v[52:55], v245 offset:19456
  ds_read_b128 v[56:59], v245 offset:20480
  ds_read_b128 v[60:63], v245 offset:21504
  ds_read_b128 v[64:67], v245 offset:22528
  ds_read_b128 v[68:71], v245 offset:23552
  s_waitcnt lgkmcnt(4)
  v_pk_add_f32 v[48:49], v[48:49], v[40:41]
  v_pk_add_f32 v[50:51], v[50:51], v[42:43]
  v_pk_add_f32 v[52:53], v[52:53], v[44:45]
  v_pk_add_f32 v[54:55], v[54:55], v[46:47]
L_fin3_join:
  s_waitcnt lgkmcnt(0)
  v_pk_add_f32 v[56:57], v[56:57], v[64:65]
  v_pk_add_f32 v[58:59], v[58:59], v[66:67]
  v_pk_add_f32 v[60:61], v[60:61], v[68:69]
  v_pk_add_f32 v[62:63], v[62:63], v[70:71]
  v_pk_add_f32 v[48:49], v[48:49], v[56:57]
  v_pk_add_f32 v[50:51], v[50:51], v[58:59]
  v_pk_add_f32 v[52:53], v[52:53], v[60:61]
  v_pk_add_f32 v[54:55], v[54:55], v[62:63]
  v_cvt_pk_bf16_f32 v56, v48, v49
  v_cvt_pk_bf16_f32 v57, v50, v51
  v_cvt_pk_bf16_f32 v58, v52, v53
  v_cvt_pk_bf16_f32 v59, v54, v55
  s_nop 1
  v_permlane32_swap_b32 v56, v58
  v_permlane32_swap_b32 v57, v59
  buffer_store_dwordx4 v[56:59], v244, s[40:43], s6 offen
L_fini:
  s_waitcnt vmcnt(0)
L_end:
  s_endpgm
L_mspina:
  s_mov_b32 s3, 1600000
L_cw_43:
  ds_read_b32 v13, v255 offset:16
  s_waitcnt lgkmcnt(0)
  v_cmp_gt_u32 vcc, 4, v13
  s_cbranch_vccz L_cw_done_44
  s_sleep 1
  s_sub_u32 s3, s3, 1
  s_cbranch_scc0 L_cw_43
L_cw_done_44:
  s_branch L_moka
L_mspinf:
  s_mov_b32 s3, 1600000
L_cw_45:
  ds_read_b32 v13, v255 offset:32
  s_waitcnt lgkmcnt(0)
  v_cmp_gt_u32 vcc, 4, v13
  s_cbranch_vccz L_cw_done_46
  s_sleep 1
  s_sub_u32 s3, s3, 1
  s_cbranch_scc0 L_cw_45
L_cw_done_46:
  s_branch L_mokf
L_retry0:
  s_mov_b32 s64, 0
  s_sub_u32 s3, s3, 1
  s_cbranch_scc0 L_rt0
  s_mov_b32 s3, 0
  s_branch L_ob0_go
L_retry1:
  s_mov_b32 s64, 1
  s_sub_u32 s3, s3, 1
  s_cbranch_scc0 L_rt1
  s_mov_b32 s3, 0
  s_branch L_ob1_go
L_retry2:
  s_mov_b32 s64, 2
  s_sub_u32 s3, s3, 1
  s_cbranch_scc0 L_rt2
  s_mov_b32 s3, 0
  s_branch L_ob2_go
L_retry3:
  s_mov_b32 s64, 3
  s_sub_u32 s3, s3, 1
  s_cbranch_scc0 L_rt3
  s_mov_b32 s3, 0
  s_branch L_ob3_go
L_retry4:
  s_mov_b32 s64, 4
  s_sub_u32 s3, s3, 1
  s_cbranch_scc0 L_rt4
  s_mov_b32 s3, 0
  s_branch L_ob4_go
L_retry5:
  s_mov_b32 s64, 5
  s_sub_u32 s3, s3, 1
  s_cbranch_scc0 L_rt5
  s_mov_b32 s3, 0
  s_branch L_ob5_go
L_retry6:
  s_mov_b32 s64, 6
  s_sub_u32 s3, s3, 1
  s_cbranch_scc0 L_rt6
  s_mov_b32 s3, 0
  s_branch L_ob6_go
L_retry7:
  s_mov_b32 s64, 7
  s_sub_u32 s3, s3, 1
  s_cbranch_scc0 L_rt7
  s_mov_b32 s3, 0
  s_branch L_ob7_go
L_rt0:
  s_cmp_eq_u32 s64, 0
  s_cbranch_scc0 L_rc0
  s_waitcnt vmcnt(0)
  s_sleep 2
L_rc0:
  v_max3_u32 v10, v208, v209, v210
  v_max_u32 v10, v10, v211
  v_cmp_eq_u32 vcc, -1, v10
  s_cbranch_vccz L_rn0
  buffer_load_dwordx4 v[208:211], v1, s[24:27], s5 offen offset:0 sc1
L_rn0:
L_rt1:
  s_cmp_eq_u32 s64, 1
  s_cbranch_scc0 L_rc1
  s_waitcnt vmcnt(0)
  s_sleep 2
L_rc1:
  v_max3_u32 v10, v212, v213, v214
  v_max_u32 v10, v10, v215
  v_cmp_eq_u32 vcc, -1, v10
  s_cbranch_vccz L_rn1
  buffer_load_dwordx4 v[212:215], v1, s[24:27], s5 offen offset:1024 sc1
L_rn1:
L_rt2:
  s_cmp_eq_u32 s64, 2
  s_cbranch_scc0 L_rc2
  s_waitcnt vmcnt(0)
  s_sleep 2
L_rc2:
  v_max3_u32 v10, v216, v217, v218
  v_max_u32 v10, v10, v219
  v_cmp_eq_u32 vcc, -1, v10
  s_cbranch_vccz L_rn2
  buffer_load_dwordx4 v[216:219], v1, s[24:27], s5 offen offset:2048 sc1
L_rn2:
L_rt3:
  s_cmp_eq_u32 s64, 3
  s_cbranch_scc0 L_rc3
  s_waitcnt vmcnt(0)
  s_sleep 2
L_rc3:
  v_max3_u32 v10, v220, v221, v222
  v_max_u32 v10, v10, v223
  v_cmp_eq_u32 vcc, -1, v10
  s_cbranch_vccz L_rn3
  buffer_load_dwordx4 v[220:223], v1, s[24:27], s5 offen offset:3072 sc1
L_rn3:
L_rt4:
  s_cmp_eq_u32 s64, 4
  s_cbranch_scc0 L_rc4
  s_waitcnt vmcnt(0)
  s_sleep 2
L_rc4:
  v_max3_u32 v10, v224, v225, v226
  v_max_u32 v10, v10, v227
  v_cmp_eq_u32 vcc, -1, v10
  s_cbranch_vccz L_rn4
  buffer_load_dwordx4 v[224:227], v1, s[24:27], s15 offen offset:0 sc1
L_rn4:
L_rt5:
  s_cmp_eq_u32 s64, 5
  s_cbranch_scc0 L_rc5
  s_waitcnt vmcnt(0)
  s_sleep 2
L_rc5:
  v_max3_u32 v10, v228, v229, v230
  v_max_u32 v10, v10, v231
  v_cmp_eq_u32 vcc, -1, v10
  s_cbranch_vccz L_rn5
  buffer_load_dwordx4 v[228:231], v1, s[24:27], s15 offen offset:1024 sc1
L_rn5:
L_rt6:
  s_cmp_eq_u32 s64, 6
  s_cbranch_scc0 L_rc6
  s_waitcnt vmcnt(0)
  s_sleep 2
L_rc6:
  v_max3_u32 v10, v232, v233, v234
  v_max_u32 v10, v10, v235
  v_cmp_eq_u32 vcc, -1, v10
  s_cbranch_vccz L_rn6
  buffer_load_dwordx4 v[232:235], v1, s[24:27], s15 offen offset:2048 sc1
L_rn6:
L_rt7:
  s_cmp_eq_u32 s64, 7
  s_cbranch_scc0 L_rc7
  s_waitcnt vmcnt(0)
  s_sleep 2
L_rc7:
  v_max3_u32 v10, v236, v237, v238
  v_max_u32 v10, v10, v239
  v_cmp_eq_u32 vcc, -1, v10
  s_cbranch_vccz L_rn7
  buffer_load_dwordx4 v[236:239], v1, s[24:27], s15 offen offset:3072 sc1
L_rn7:
  s_waitcnt vmcnt(0)
  s_cmp_eq_u32 s64, 0
  s_cbranch_scc1 L_ob0
  s_cmp_eq_u32 s64, 1
  s_cbranch_scc1 L_ob1
  s_cmp_eq_u32 s64, 2
  s_cbranch_scc1 L_ob2
  s_cmp_eq_u32 s64, 3
  s_cbranch_scc1 L_ob3
  s_cmp_eq_u32 s64, 4
  s_cbranch_scc1 L_ob4
  s_cmp_eq_u32 s64, 5
  s_cbranch_scc1 L_ob5
  s_cmp_eq_u32 s64, 6
  s_cbranch_scc1 L_ob6
  s_branch L_ob7
L_slowA:
  s_sub_i32 s11, s59, 8
  s_max_i32 s11, s11, 0
  s_add_u32 s65, s59, 1
  v_mov_b32 v144, 0xff800000
  v_mov_b32 v147, 0xff800000
  v_mov_b32 v120, 0
  v_mov_b32 v121, 0
  v_mov_b32 v122, 0
  v_mov_b32 v123, 0
  v_mov_b32 v124, 0
  v_mov_b32 v125, 0
  v_mov_b32 v126, 0
  v_mov_b32 v127, 0
  v_mov_b32 v128, 0
  v_mov_b32 v129, 0
  v_mov_b32 v130, 0
  v_mov_b32 v131, 0
  v_mov_b32 v132, 0
  v_mov_b32 v133, 0
  v_mov_b32 v134, 0
  v_mov_b32 v135, 0
  s_mov_b32 s64, s11
L_slowA_p0:
  s_lshl_b32 s10, s64, 12
  buffer_load_dwordx4 v[40:43], v1, s[28:31], s10 offen offset:0 sc1
  buffer_load_dwordx4 v[44:47], v1, s[28:31], s10 offen offset:1024 sc1
  s_sub_u32 s66, s59, s64
  s_lshl_b32 s66, s66, 5
  v_lshrrev_b32 v145, 5, v0
  v_lshlrev_b32 v145, 2, v145
  v_sub_u32 v145, v7, v145
  v_add_u32 v145, s66, v145
  s_waitcnt vmcnt(0)
  v_mfma_f32_32x32x16_bf16 v[104:119], v[40:43], v[16:19], 0
  v_mfma_f32_32x32x16_bf16 v[104:119], v[44:47], v[20:23], v[104:119]
  s_nop 15
  v_subrev_u32 v146, 0, v145
  v_cmp_gt_u32 vcc, 0x100, v146
  s_nop 1
  v_cndmask_b32 v104, v147, v104, vcc
  v_subrev_u32 v146, 1, v145
  v_cmp_gt_u32 vcc, 0x100, v146
  s_nop 1
  v_cndmask_b32 v105, v147, v105, vcc
  v_subrev_u32 v146, 2, v145
  v_cmp_gt_u32 vcc, 0x100, v146
  s_nop 1
  v_cndmask_b32 v106, v147, v106, vcc
  v_subrev_u32 v146, 3, v145
  v_cmp_gt_u32 vcc, 0x100, v146
  s_nop 1
  v_cndmask_b32 v107, v147, v107, vcc
  v_subrev_u32 v146, 8, v145
  v_cmp_gt_u32 vcc, 0x100, v146
  s_nop 1
  v_cndmask_b32 v108, v147, v108, vcc
  v_subrev_u32 v146, 9, v145
  v_cmp_gt_u32 vcc, 0x100, v146
  s_nop 1
  v_cndmask_b32 v109, v147, v109, vcc
  v_subrev_u32 v146, 10, v145
  v_cmp_gt_u32 vcc, 0x100, v146
  s_nop 1
  v_cndmask_b32 v110, v147, v110, vcc
  v_subrev_u32 v146, 11, v145
  v_cmp_gt_u32 vcc, 0x100, v146
  s_nop 1
  v_cndmask_b32 v111, v147, v111, vcc
  v_subrev_u32 v146, 16, v145
  v_cmp_gt_u32 vcc, 0x100, v146
  s_nop 1
  v_cndmask_b32 v112, v147, v112, vcc
  v_subrev_u32 v146, 17, v145
  v_cmp_gt_u32 vcc, 0x100, v146
  s_nop 1
  v_cndmask_b32 v113, v147, v113, vcc
  v_subrev_u32 v146, 18, v145
  v_cmp_gt_u32 vcc, 0x100, v146
  s_nop 1
  v_cndmask_b32 v114, v147, v114, vcc
  v_subrev_u32 v146, 19, v145
  v_cmp_gt_u32 vcc, 0x100, v146
  s_nop 1
  v_cndmask_b32 v115, v147, v115, vcc
  v_subrev_u32 v146, 24, v145
  v_cmp_gt_u32 vcc, 0x100, v146
  s_nop 1
  v_cndmask_b32 v116, v147, v116, vcc
  v_subrev_u32 v146, 25, v145
  v_cmp_gt_u32 vcc, 0x100, v146
  s_nop 1
  v_cndmask_b32 v117, v147, v117, vcc
  v_subrev_u32 v146, 26, v145
  v_cmp_gt_u32 vcc, 0x100, v146
  s_nop 1
  v_cndmask_b32 v118, v147, v118, vcc
  v_subrev_u32 v146, 27, v145
  v_cmp_gt_u32 vcc, 0x100, v146
  s_nop 1
  v_cndmask_b32 v119, v147, v119, vcc
  v_max_f32 v144, v144, v104
  v_max_f32 v144, v144, v105
  v_max_f32 v144, v144, v106
  v_max_f32 v144, v144, v107
  v_max_f32 v144, v144, v108
  v_max_f32 v144, v144, v109
  v_max_f32 v144, v144, v110
  v_max_f32 v144, v144, v111
  v_max_f32 v144, v144, v112
  v_max_f32 v144, v144, v113
  v_max_f32 v144, v144, v114
  v_max_f32 v144, v144, v115
  v_max_f32 v144, v144, v116
  v_max_f32 v144, v144, v117
  v_max_f32 v144, v144, v118
  v_max_f32 v144, v144, v119
  s_add_u32 s64, s64, 1
  s_cmp_lt_u32 s64, s65
  s_cbranch_scc1 L_slowA_p0
  v_mov_b32 v145, v144
  s_nop 1
  v_permlane32_swap_b32 v144, v145
  s_nop 1
  v_max_f32 v144, v144, v145
  s_mov_b32 s64, s11
L_slowA_p1:
  s_lshl_b32 s10, s64, 12
  buffer_load_dwordx4 v[40:43], v1, s[28:31], s10 offen offset:0 sc1
  buffer_load_dwordx4 v[44:47], v1, s[28:31], s10 offen offset:1024 sc1
  buffer_load_dwordx4 v[48:51], v1, s[28:31], s10 offen offset:2048 sc1
  buffer_load_dwordx4 v[52:55], v1, s[28:31], s10 offen offset:3072 sc1
  s_sub_u32 s66, s59, s64
  s_lshl_b32 s66, s66, 5
  v_lshrrev_b32 v145, 5, v0
  v_lshlrev_b32 v145, 2, v145
  v_sub_u32 v145, v7, v145
  v_add_u32 v145, s66, v145
  s_waitcnt vmcnt(0)
  v_mfma_f32_32x32x16_bf16 v[104:119], v[40:43], v[16:19], 0
  v_mfma_f32_32x32x16_bf16 v[104:119], v[44:47], v[20:23], v[104:119]
  s_nop 15
  v_subrev_u32 v146, 0, v145
  v_cmp_gt_u32 vcc, 0x100, v146
  s_nop 1
  v_cndmask_b32 v104, v147, v104, vcc
  v_subrev_u32 v146, 1, v145
  v_cmp_gt_u32 vcc, 0x100, v146
  s_nop 1
  v_cndmask_b32 v105, v147, v105, vcc
  v_subrev_u32 v146, 2, v145
  v_cmp_gt_u32 vcc, 0x100, v146
  s_nop 1
  v_cndmask_b32 v106, v147, v106, vcc
  v_subrev_u32 v146, 3, v145
  v_cmp_gt_u32 vcc, 0x100, v146
  s_nop 1
  v_cndmask_b32 v107, v147, v107, vcc
  v_subrev_u32 v146, 8, v145
  v_cmp_gt_u32 vcc, 0x100, v146
  s_nop 1
  v_cndmask_b32 v108, v147, v108, vcc
  v_subrev_u32 v146, 9, v145
  v_cmp_gt_u32 vcc, 0x100, v146
  s_nop 1
  v_cndmask_b32 v109, v147, v109, vcc
  v_subrev_u32 v146, 10, v145
  v_cmp_gt_u32 vcc, 0x100, v146
  s_nop 1
  v_cndmask_b32 v110, v147, v110, vcc
  v_subrev_u32 v146, 11, v145
  v_cmp_gt_u32 vcc, 0x100, v146
  s_nop 1
  v_cndmask_b32 v111, v147, v111, vcc
  v_subrev_u32 v146, 16, v145
  v_cmp_gt_u32 vcc, 0x100, v146
  s_nop 1
  v_cndmask_b32 v112, v147, v112, vcc
  v_subrev_u32 v146, 17, v145
  v_cmp_gt_u32 vcc, 0x100, v146
  s_nop 1
  v_cndmask_b32 v113, v147, v113, vcc
  v_subrev_u32 v146, 18, v145
  v_cmp_gt_u32 vcc, 0x100, v146
  s_nop 1
  v_cndmask_b32 v114, v147, v114, vcc
  v_subrev_u32 v146, 19, v145
  v_cmp_gt_u32 vcc, 0x100, v146
  s_nop 1
  v_cndmask_b32 v115, v147, v115, vcc
  v_subrev_u32 v146, 24, v145
  v_cmp_gt_u32 vcc, 0x100, v146
  s_nop 1
  v_cndmask_b32 v116, v147, v116, vcc
  v_subrev_u32 v146, 25, v145
  v_cmp_gt_u32 vcc, 0x100, v146
  s_nop 1
  v_cndmask_b32 v117, v147, v117, vcc
  v_subrev_u32 v146, 26, v145
  v_cmp_gt_u32 vcc, 0x100, v146
  s_nop 1
  v_cndmask_b32 v118, v147, v118, vcc
  v_subrev_u32 v146, 27, v145
  v_cmp_gt_u32 vcc, 0x100, v146
  s_nop 1
  v_cndmask_b32 v119, v147, v119, vcc
  v_sub_f32 v104, v104, v144
  v_sub_f32 v105, v105, v144
  v_sub_f32 v106, v106, v144
  v_sub_f32 v107, v107, v144
  v_sub_f32 v108, v108, v144
  v_sub_f32 v109, v109, v144
  v_sub_f32 v110, v110, v144
  v_sub_f32 v111, v111, v144
  v_sub_f32 v112, v112, v144
  v_sub_f32 v113, v113, v144
  v_sub_f32 v114, v114, v144
  v_sub_f32 v115, v115, v144
  v_sub_f32 v116, v116, v144
  v_sub_f32 v117, v117, v144
  v_sub_f32 v118, v118, v144
  v_sub_f32 v119, v119, v144
  v_exp_f32 v104, v104
  v_exp_f32 v105, v105
  v_exp_f32 v106, v106
  v_exp_f32 v107, v107
  v_exp_f32 v108, v108
  v_exp_f32 v109, v109
  v_exp_f32 v110, v110
  v_exp_f32 v111, v111
  v_exp_f32 v112, v112
  v_exp_f32 v113, v113
  v_exp_f32 v114, v114
  v_exp_f32 v115, v115
  v_exp_f32 v116, v116
  v_exp_f32 v117, v117
  v_exp_f32 v118, v118
  v_exp_f32 v119, v119
  s_nop 1
  v_smfmac_f32_32x32x32_bf16 v[120:135], v[48:51], v[104:111], v6
  v_smfmac_f32_32x32x32_bf16 v[120:135], v[52:55], v[112:119], v6
  s_add_u32 s64, s64, 1
  s_cmp_lt_u32 s64, s65
  s_cbranch_scc1 L_slowA_p1
  s_nop 15
  v_mov_b32 v145, v132
  v_mov_b32 v3, v132
  s_nop 1
  v_permlane32_swap_b32 v145, v3
  s_nop 1
  v_rcp_f32 v3, v3
  s_nop 0
  v_mul_f32 v3, v3, v8
  v_mul_f32 v88, v120, v3
  v_mul_f32 v89, v121, v3
  v_mul_f32 v90, v122, v3
  v_mul_f32 v91, v123, v3
  v_mul_f32 v92, v124, v3
  v_mul_f32 v93, v125, v3
  v_mul_f32 v94, v126, v3
  v_mul_f32 v95, v127, v3
  v_mul_f32 v96, v128, v3
  v_mul_f32 v97, v129, v3
  v_mul_f32 v98, v130, v3
  v_mul_f32 v99, v131, v3
  v_mul_f32 v100, v132, v3
  v_mul_f32 v101, v133, v3
  v_mul_f32 v102, v134, v3
  v_mul_f32 v103, v135, v3
  s_branch L_finA
L_slowB0:
  s_mov_b32 s11, 0
  s_mov_b32 s65, 64
  v_mov_b32 v144, 0xff800000
  v_mov_b32 v147, 0xff800000
  v_mov_b32 v120, 0
  v_mov_b32 v121, 0
  v_mov_b32 v122, 0
  v_mov_b32 v123, 0
  v_mov_b32 v124, 0
  v_mov_b32 v125, 0
  v_mov_b32 v126, 0
  v_mov_b32 v127, 0
  v_mov_b32 v128, 0
  v_mov_b32 v129, 0
  v_mov_b32 v130, 0
  v_mov_b32 v131, 0
  v_mov_b32 v132, 0
  v_mov_b32 v133, 0
  v_mov_b32 v134, 0
  v_mov_b32 v135, 0
  s_mov_b32 s64, s11
L_slowB0_p0:
  s_lshl_b32 s10, s64, 12
  s_add_u32 s10, s10, s1
  buffer_load_dwordx4 v[40:43], v1, s[24:27], s10 offen offset:0 sc1
  buffer_load_dwordx4 v[44:47], v1, s[24:27], s10 offen offset:1024 sc1
  s_waitcnt vmcnt(0)
  v_mfma_f32_32x32x16_bf16 v[104:119], v[40:43], v[24:27], 0
  v_mfma_f32_32x32x16_bf16 v[104:119], v[44:47], v[28:31], v[104:119]
  s_nop 15
  v_max_f32 v144, v144, v104
  v_max_f32 v144, v144, v105
  v_max_f32 v144, v144, v106
  v_max_f32 v144, v144, v107
  v_max_f32 v144, v144, v108
  v_max_f32 v144, v144, v109
  v_max_f32 v144, v144, v110
  v_max_f32 v144, v144, v111
  v_max_f32 v144, v144, v112
  v_max_f32 v144, v144, v113
  v_max_f32 v144, v144, v114
  v_max_f32 v144, v144, v115
  v_max_f32 v144, v144, v116
  v_max_f32 v144, v144, v117
  v_max_f32 v144, v144, v118
  v_max_f32 v144, v144, v119
  s_add_u32 s64, s64, 1
  s_cmp_lt_u32 s64, s65
  s_cbranch_scc1 L_slowB0_p0
  v_mov_b32 v145, v144
  s_nop 1
  v_permlane32_swap_b32 v144, v145
  s_nop 1
  v_max_f32 v144, v144, v145
  s_mov_b32 s64, s11
L_slowB0_p1:
  s_lshl_b32 s10, s64, 12
  s_add_u32 s10, s10, s1
  buffer_load_dwordx4 v[40:43], v1, s[24:27], s10 offen offset:0 sc1
  buffer_load_dwordx4 v[44:47], v1, s[24:27], s10 offen offset:1024 sc1
  buffer_load_dwordx4 v[48:51], v1, s[24:27], s10 offen offset:2048 sc1
  buffer_load_dwordx4 v[52:55], v1, s[24:27], s10 offen offset:3072 sc1
  s_waitcnt vmcnt(0)
  v_mfma_f32_32x32x16_bf16 v[104:119], v[40:43], v[24:27], 0
  v_mfma_f32_32x32x16_bf16 v[104:119], v[44:47], v[28:31], v[104:119]
  s_nop 15
  v_sub_f32 v104, v104, v144
  v_sub_f32 v105, v105, v144
  v_sub_f32 v106, v106, v144
  v_sub_f32 v107, v107, v144
  v_sub_f32 v108, v108, v144
  v_sub_f32 v109, v109, v144
  v_sub_f32 v110, v110, v144
  v_sub_f32 v111, v111, v144
  v_sub_f32 v112, v112, v144
  v_sub_f32 v113, v113, v144
  v_sub_f32 v114, v114, v144
  v_sub_f32 v115, v115, v144
  v_sub_f32 v116, v116, v144
  v_sub_f32 v117, v117, v144
  v_sub_f32 v118, v118, v144
  v_sub_f32 v119, v119, v144
  v_exp_f32 v104, v104
  v_exp_f32 v105, v105
  v_exp_f32 v106, v106
  v_exp_f32 v107, v107
  v_exp_f32 v108, v108
  v_exp_f32 v109, v109
  v_exp_f32 v110, v110
  v_exp_f32 v111, v111
  v_exp_f32 v112, v112
  v_exp_f32 v113, v113
  v_exp_f32 v114, v114
  v_exp_f32 v115, v115
  v_exp_f32 v116, v116
  v_exp_f32 v117, v117
  v_exp_f32 v118, v118
  v_exp_f32 v119, v119
  s_nop 1
  v_smfmac_f32_32x32x32_bf16 v[120:135], v[48:51], v[104:111], v6
  v_smfmac_f32_32x32x32_bf16 v[120:135], v[52:55], v[112:119], v6
  s_add_u32 s64, s64, 1
  s_cmp_lt_u32 s64, s65
  s_cbranch_scc1 L_slowB0_p1
  s_nop 15
  v_mov_b32 v145, v132
  v_mov_b32 v136, v132
  s_nop 1
  v_permlane32_swap_b32 v145, v136
  s_nop 1
  v_rcp_f32 v136, v136
  s_nop 0
  v_mul_f32 v136, v136, v9
  s_bitcmp1_b32 s52, 0
  s_cbranch_scc1 L_slowB0_odd
  v_mul_f32 v56, v120, v136
  v_mul_f32 v57, v121, v136
  v_mul_f32 v58, v122, v136
  v_mul_f32 v59, v123, v136
  v_mul_f32 v60, v124, v136
  v_mul_f32 v61, v125, v136
  v_mul_f32 v62, v126, v136
  v_mul_f32 v63, v127, v136
  s_branch L_finB0
L_slowB0_odd:
  v_mul_f32 v56, v128, v136
  v_mul_f32 v57, v129, v136
  v_mul_f32 v58, v130, v136
  v_mul_f32 v59, v131, v136
  v_mul_f32 v60, v132, v136
  v_mul_f32 v61, v133, v136
  v_mul_f32 v62, v134, v136
  v_mul_f32 v63, v135, v136
  s_branch L_finB0
L_slowB1:
  s_mov_b32 s11, 0
  s_mov_b32 s65, 64
  v_mov_b32 v144, 0xff800000
  v_mov_b32 v147, 0xff800000
  v_mov_b32 v120, 0
  v_mov_b32 v121, 0
  v_mov_b32 v122, 0
  v_mov_b32 v123, 0
  v_mov_b32 v124, 0
  v_mov_b32 v125, 0
  v_mov_b32 v126, 0
  v_mov_b32 v127, 0
  v_mov_b32 v128, 0
  v_mov_b32 v129, 0
  v_mov_b32 v130, 0
  v_mov_b32 v131, 0
  v_mov_b32 v132, 0
  v_mov_b32 v133, 0
  v_mov_b32 v134, 0
  v_mov_b32 v135, 0
  s_mov_b32 s64, s11
L_slowB1_p0:
  s_lshl_b32 s10, s64, 12
  s_add_u32 s10, s10, s1
  buffer_load_dwordx4 v[40:43], v1, s[24:27], s10 offen offset:0 sc1
  buffer_load_dwordx4 v[44:47], v1, s[24:27], s10 offen offset:1024 sc1
  s_waitcnt vmcnt(0)
  v_mfma_f32_32x32x16_bf16 v[104:119], v[40:43], v[32:35], 0
  v_mfma_f32_32x32x16_bf16 v[104:119], v[44:47], v[36:39], v[104:119]
  s_nop 15
  v_max_f32 v144, v144, v104
  v_max_f32 v144, v144, v105
  v_max_f32 v144, v144, v106
  v_max_f32 v144, v144, v107
  v_max_f32 v144, v144, v108
  v_max_f32 v144, v144, v109
  v_max_f32 v144, v144, v110
  v_max_f32 v144, v144, v111
  v_max_f32 v144, v144, v112
  v_max_f32 v144, v144, v113
  v_max_f32 v144, v144, v114
  v_max_f32 v144, v144, v115
  v_max_f32 v144, v144, v116
  v_max_f32 v144, v144, v117
  v_max_f32 v144, v144, v118
  v_max_f32 v144, v144, v119
  s_add_u32 s64, s64, 1
  s_cmp_lt_u32 s64, s65
  s_cbranch_scc1 L_slowB1_p0
  v_mov_b32 v145, v144
  s_nop 1
  v_permlane32_swap_b32 v144, v145
  s_nop 1
  v_max_f32 v144, v144, v145
  s_mov_b32 s64, s11
L_slowB1_p1:
  s_lshl_b32 s10, s64, 12
  s_add_u32 s10, s10, s1
  buffer_load_dwordx4 v[40:43], v1, s[24:27], s10 offen offset:0 sc1
  buffer_load_dwordx4 v[44:47], v1, s[24:27], s10 offen offset:1024 sc1
  buffer_load_dwordx4 v[48:51], v1, s[24:27], s10 offen offset:2048 sc1
  buffer_load_dwordx4 v[52:55], v1, s[24:27], s10 offen offset:3072 sc1
  s_waitcnt vmcnt(0)
  v_mfma_f32_32x32x16_bf16 v[104:119], v[40:43], v[32:35], 0
  v_mfma_f32_32x32x16_bf16 v[104:119], v[44:47], v[36:39], v[104:119]
  s_nop 15
  v_sub_f32 v104, v104, v144
  v_sub_f32 v105, v105, v144
  v_sub_f32 v106, v106, v144
  v_sub_f32 v107, v107, v144
  v_sub_f32 v108, v108, v144
  v_sub_f32 v109, v109, v144
  v_sub_f32 v110, v110, v144
  v_sub_f32 v111, v111, v144
  v_sub_f32 v112, v112, v144
  v_sub_f32 v113, v113, v144
  v_sub_f32 v114, v114, v144
  v_sub_f32 v115, v115, v144
  v_sub_f32 v116, v116, v144
  v_sub_f32 v117, v117, v144
  v_sub_f32 v118, v118, v144
  v_sub_f32 v119, v119, v144
  v_exp_f32 v104, v104
  v_exp_f32 v105, v105
  v_exp_f32 v106, v106
  v_exp_f32 v107, v107
  v_exp_f32 v108, v108
  v_exp_f32 v109, v109
  v_exp_f32 v110, v110
  v_exp_f32 v111, v111
  v_exp_f32 v112, v112
  v_exp_f32 v113, v113
  v_exp_f32 v114, v114
  v_exp_f32 v115, v115
  v_exp_f32 v116, v116
  v_exp_f32 v117, v117
  v_exp_f32 v118, v118
  v_exp_f32 v119, v119
  s_nop 1
  v_smfmac_f32_32x32x32_bf16 v[120:135], v[48:51], v[104:111], v6
  v_smfmac_f32_32x32x32_bf16 v[120:135], v[52:55], v[112:119], v6
  s_add_u32 s64, s64, 1
  s_cmp_lt_u32 s64, s65
  s_cbranch_scc1 L_slowB1_p1
  s_nop 15
  v_mov_b32 v145, v132
  v_mov_b32 v136, v132
  s_nop 1
  v_permlane32_swap_b32 v145, v136
  s_nop 1
  v_rcp_f32 v136, v136
  s_nop 0
  v_mul_f32 v136, v136, v248
  s_bitcmp1_b32 s52, 0
  s_cbranch_scc1 L_slowB1_odd
  v_mul_f32 v56, v120, v136
  v_mul_f32 v57, v121, v136
  v_mul_f32 v58, v122, v136
  v_mul_f32 v59, v123, v136
  v_mul_f32 v60, v124, v136
  v_mul_f32 v61, v125, v136
  v_mul_f32 v62, v126, v136
  v_mul_f32 v63, v127, v136
  s_branch L_finB1
L_slowB1_odd:
  v_mul_f32 v56, v128, v136
  v_mul_f32 v57, v129, v136
  v_mul_f32 v58, v130, v136
  v_mul_f32 v59, v131, v136
  v_mul_f32 v60, v132, v136
  v_mul_f32 v61, v133, v136
  v_mul_f32 v62, v134, v136
  v_mul_f32 v63, v135, v136
  s_branch L_finB1
L_code_end:
.section .rodata,"a"
.p2align 6
.amdhsa_kernel gated_mix__sliding_block__softmax_full_mha__prompt_kernel
  .amdhsa_next_free_vgpr 256
  .amdhsa_next_free_sgpr 102
  .amdhsa_accum_offset 256
  .amdhsa_group_segment_fixed_size 0
  .amdhsa_kernarg_size 80
  .amdhsa_user_sgpr_count 2
  .amdhsa_user_sgpr_kernarg_segment_ptr 1
  .amdhsa_system_sgpr_workgroup_id_x 1
.end_amdhsa_kernel
```
